```python
import torch

def _softmax(x, axis=-1):
    return torch.softmax(x, dim=axis)
def _gelu(x):
    return torch.nn.functional.gelu(x, approximate="tanh")
def _silu(x):
    return torch.nn.functional.silu(x)
def _sigmoid(x):
    return torch.sigmoid(x)
def _layernorm(x, axis=-1, eps=1e-5):
    m = x.mean(dim=axis, keepdim=True)
    v = x.var(dim=axis, keepdim=True, unbiased=False)
    return (x - m) / torch.sqrt(v + eps)
def _scatter_add(tgt, idx, src, axis=0):
    return tgt.clone().index_add_(axis, idx, src)
def _segment_sum(src, seg, n):
    out = torch.zeros((n,) + src.shape[1:], dtype=src.dtype)
    return out.index_add_(0, seg, src)
def _pad(x, pw):
    flat = tuple(v for pair in reversed(pw) for v in pair)
    return torch.nn.functional.pad(x, flat)

kernel_name = 'parallel_sum__compressed_kv_cla__dense_activation_squared_relu__decode'

def setup_inputs():

    _w = (lambda a: (lambda t: t.to(torch.bfloat16) if t.is_floating_point() else t)(torch.as_tensor(a)))
    def _A_setup():
        B, H, Sq, Sk, D, M = 4, 32, 1, 4096, 128, 512
        Dc = 4 * D
        return {
            "x": _w((lambda *s: torch.randn(*s, dtype=torch.bfloat16) * 0.05)(B, Sq, M)),
            "c_kv": _w((lambda *s: torch.randn(*s, dtype=torch.bfloat16) * 3.2)(B, Sk, Dc)),
            "w_q": _w((lambda *s: torch.randn(*s, dtype=torch.bfloat16) * 1.6)(M, H, D) * (M ** -0.5)),
            "w_uk": _w((lambda *s: torch.randn(*s, dtype=torch.bfloat16) * 1.6)(Dc, H, D) * (Dc ** -0.5)),
            "w_uv": _w((lambda *s: torch.randn(*s, dtype=torch.bfloat16) * 3.2)(Dc, H, D) * (Dc ** -0.5)),
            "w_o": _w((lambda *s: torch.randn(*s, dtype=torch.bfloat16) * 3.2)(H, D, M) * ((H * D) ** -0.5)),
        }
    _A_in = _A_setup()

    def _B_setup():
        B, S, D, F = 4, 1, 512, 1792
        return {
            "x": _w((lambda *s: torch.randn(*s, dtype=torch.bfloat16) * 0.05)(B, S, D)),
            "w1": _w((lambda *s: torch.randn(*s, dtype=torch.bfloat16) * 0.1)(D, F)),
            "b1": _w((lambda *s: torch.randn(*s, dtype=torch.bfloat16) * 0.8)(F)),
            "w2": _w((lambda *s: torch.randn(*s, dtype=torch.bfloat16) * 0.1)(F, D)),
            "b2": _w((lambda *s: torch.randn(*s, dtype=torch.bfloat16) * 12.8)(D)),
        }
    _B_in = _B_setup()

    return {
        "A_x": _A_in["x"],
        "A_c_kv": _A_in["c_kv"],
        "A_w_q": _A_in["w_q"],
        "A_w_uk": _A_in["w_uk"],
        "A_w_uv": _A_in["w_uv"],
        "A_w_o": _A_in["w_o"],
        "B_x": _B_in["x"],
        "B_w1": _B_in["w1"],
        "B_b1": _B_in["b1"],
        "B_w2": _B_in["w2"],
        "B_b2": _B_in["b2"],
    }

def reference(A_x, A_c_kv, A_w_q, A_w_uk, A_w_uv, A_w_o, B_x, B_w1, B_b1, B_w2, B_b2):
    def _A_ref(x, c_kv, w_q, w_uk, w_uv, w_o):
        B, Sq, M = x.shape[0], x.shape[1], x.shape[2]
        Sk = c_kv.shape[1]
        H, D = w_q.shape[1], w_q.shape[2]
        q = torch.einsum("bqm,mhd->bhqd", x, w_q)
        k = torch.einsum("bkc,chd->bhkd", c_kv, w_uk)
        v = torch.einsum("bkc,chd->bhkd", c_kv, w_uv)
        scores = torch.einsum("bhqd,bhkd->bhqk", q, k) * (D ** -0.5)
        off = Sk - Sq
        qi = torch.arange(Sq)[:, None]
        kj = torch.arange(Sk)[None, :]
        cmask = kj <= (qi + off)
        scores = torch.where(cmask[None, None], scores, -1e9)
        p = _softmax(scores, axis=-1)
        ctx = torch.einsum("bhqk,bhkd->bhqd", p, v)
        return torch.einsum("bhqd,hdm->bqm", ctx, w_o)

    def _B_ref(x, w1, b1, w2, b2):
        h = torch.einsum("bsd,df->bsf", x, w1) + b1
        zero = torch.zeros_like(h)
        r = torch.where(h > zero, h, zero)
        h = r * r
        out = torch.einsum("bsf,fd->bsd", h, w2) + b2
        return out

    x = A_x
    xn = _layernorm(x, axis=-1)
    return x + _A_ref(xn, A_c_kv, A_w_q, A_w_uk, A_w_uv, A_w_o) + _B_ref(xn, B_w1, B_b1, B_w2, B_b2)
```

```asm
; @launch grid=(256,1,1) block=(512,1,1) lds=162816
.amdgcn_target "amdgcn-amd-amdhsa--gfx950"
.text
.globl parallel_sum__compressed_kv_cla__dense_activation_squared_relu__decode_kernel
.p2align 8
.type parallel_sum__compressed_kv_cla__dense_activation_squared_relu__decode_kernel,@function
parallel_sum__compressed_kv_cla__dense_activation_squared_relu__decode_kernel:
    s_cmp_ge_u32 s2, 256
    s_cbranch_scc1 L_END
    s_load_dwordx2 s[32:33], s[0:1], 0
    s_load_dwordx2 s[40:41], s[0:1], 16
    s_load_dwordx2 s[44:45], s[0:1], 24
    s_load_dwordx2 s[80:81], s[0:1], 104
    s_load_dwordx2 s[36:37], s[0:1], 8
    s_load_dwordx2 s[76:77], s[0:1], 96
    s_mov_b32 s34, 4096
    s_mov_b32 s35, 0x20000
    s_mov_b32 s38, 16777216
    s_mov_b32 s39, 0x20000
    s_mov_b32 s42, 4194304
    s_mov_b32 s43, 0x20000
    s_mov_b32 s46, 4194304
    s_mov_b32 s47, 0x20000
    s_mov_b32 s50, 4194304
    s_mov_b32 s51, 0x20000
    s_mov_b32 s54, 4194304
    s_mov_b32 s55, 0x20000
    s_mov_b32 s58, 1835008
    s_mov_b32 s59, 0x20000
    s_mov_b32 s62, 3584
    s_mov_b32 s63, 0x20000
    s_mov_b32 s66, 1835008
    s_mov_b32 s67, 0x20000
    s_mov_b32 s70, 1024
    s_mov_b32 s71, 0x20000
    s_mov_b32 s74, 4096
    s_mov_b32 s75, 0x20000
    s_mov_b32 s78, 256
    s_mov_b32 s79, 0x20000
    s_mov_b32 s82, 268435456
    s_mov_b32 s83, 0x20000
    v_and_b32 v1, 63, v0
    v_and_b32 v2, 15, v0
    v_bfe_u32 v3, v0, 4, 2
    v_lshrrev_b32 v4, 6, v0
    s_and_b32 s85, s2, 7
    v_readfirstlane_b32 s84, v4
    s_lshr_b32 s86, s2, 3
    s_lshr_b32 s92, s86, 3
    s_lshl_b32 s87, s85, 2
    s_bfe_u32 s99, s86, 0x20002
    s_add_u32 s99, s99, s87
    s_add_u32 s87, s87, s92
    s_and_b32 s88, s86, 7
    s_and_b32 s3, s86, 3
    s_lshr_b32 s97, s86, 4
    s_and_b32 s98, s86, 15
    s_getreg_b32 s91, hwreg(HW_REG_XCC_ID)
    s_and_b32 s91, s91, 0x3f
    s_or_b32 s91, s91, 0x80
    v_mov_b32 v7, 0
    v_mov_b32 v21, 0
    v_lshlrev_b32 v5, 2, v2
    ds_write_b32 v5, v7 offset:4160
    v_lshlrev_b32 v6, 4, v1
    v_lshlrev_b32 v8, 13, v3
    v_lshl_add_u32 v8, v2, 4, v8
    s_lshl_b32 s95, s87, 3
    s_add_u32 s95, s95, s88
    v_lshrrev_b32 v12, 5, v1
    v_mul_u32_u24 v12, 272, v12
    v_and_b32 v13, 31, v1
    v_lshl_add_u32 v12, v13, 3, v12
    s_lshl_b32 s28, s85, 21
    s_lshl_b32 s93, s98, 17
    s_add_u32 s28, s28, s93
    s_lshl_b32 s93, s84, 10
    s_add_u32 s28, s28, s93
    s_mul_i32 s29, s84, 1040
    s_add_u32 s29, s29, 29696
    s_and_b32 s92, s84, 3
    s_lshl_b32 s92, s92, 10
    s_waitcnt lgkmcnt(0)
    buffer_load_dwordx4 v[16:19], v6, s[32:35], s92 offen
    buffer_load_dword v20, v7, s[80:83], 0 offen sc1
    s_load_dwordx2 s[48:49], s[0:1], 32
    s_load_dwordx2 s[52:53], s[0:1], 40
    s_load_dwordx2 s[56:57], s[0:1], 56
    s_load_dwordx2 s[64:65], s[0:1], 72
    s_load_dwordx2 s[60:61], s[0:1], 64
    s_load_dwordx2 s[68:69], s[0:1], 80
    s_load_dwordx2 s[72:73], s[0:1], 88
    s_cmp_eq_u32 s97, 0
    s_cbranch_scc1 L_STREAMER
    v_lshlrev_b32 v9, 13, v2
    v_lshl_add_u32 v9, v3, 4, v9
    s_lshl_b32 s94, s99, 8
    s_lshl_b32 s92, s3, 3
    s_add_u32 s92, s92, s84
    s_lshl_b32 s92, s92, 17
    s_add_u32 s92, s92, s94
    buffer_load_dwordx4 v[24:27], v9, s[44:47], s92 offen offset:0
    buffer_load_dwordx4 v[28:31], v9, s[44:47], s92 offen offset:64
    buffer_load_dwordx4 v[32:35], v9, s[44:47], s92 offen offset:128
    buffer_load_dwordx4 v[36:39], v9, s[44:47], s92 offen offset:192
    s_lshl_b32 s94, s99, 13
    s_lshl_b32 s31, s84, 10
    s_add_u32 s94, s94, s31
    s_add_u32 s94, s94, 3145728
    s_mul_i32 s31, s84, 544
    v_add_u32 v13, s31, v12
    v_mul_u32_u24 v14, 272, v2
    v_lshl_add_u32 v14, v3, 4, v14
    v_lshlrev_b32 v11, 16, v2
    v_lshl_add_u32 v11, v3, 4, v11
    s_lshl_b32 s92, s99, 11
    s_lshl_b32 s93, s3, 9
    s_add_u32 s92, s92, s93
    s_lshl_b32 s93, s84, 6
    s_add_u32 s92, s92, s93
    s_add_u32 s92, s92, 131072
    s_waitcnt vmcnt(0)
    v_readfirstlane_b32 s89, v20
    s_add_u32 s89, s89, 1
    v_mov_b32 v102, s89
    v_mov_b32 v103, s89
    s_mov_b32 s96, 0
pq_loop:
    s_and_b32 s30, s96, 15
    s_cmp_eq_u32 s30, 15
    s_cselect_b32 s30, 524288, 0
    s_add_u32 s30, s30, s94
    buffer_load_dwordx4 v[40:43], v6, s[80:83], s30 offen sc1
    s_waitcnt vmcnt(0)
    v_cmp_ne_u32 vcc, s89, v42
    v_cmp_ne_u32 s[100:101], s89, v43
    s_or_b64 vcc, vcc, s[100:101]
    s_cbranch_vccz pq_done
    s_add_u32 s96, s96, 1
    s_sleep 2
    s_cmp_lt_u32 s96, 200000
    s_cbranch_scc1 pq_loop
pq_done:
    ds_write_b64 v13, v[40:41] offset:4352
    s_waitcnt lgkmcnt(0)
    s_barrier
    ds_read_b128 v[40:43], v14 offset:4352
    ds_read_b128 v[44:47], v14 offset:4416
    ds_read_b128 v[48:51], v14 offset:4480
    ds_read_b128 v[52:55], v14 offset:4544
    v_cmp_gt_u32 vcc, 4, v2
    s_waitcnt lgkmcnt(3)
    v_mfma_f32_16x16x32_bf16 v[96:99], v[24:27], v[40:43], 0
    s_waitcnt lgkmcnt(2)
    v_mfma_f32_16x16x32_bf16 v[96:99], v[28:31], v[44:47], v[96:99]
    s_waitcnt lgkmcnt(1)
    v_mfma_f32_16x16x32_bf16 v[96:99], v[32:35], v[48:51], v[96:99]
    s_waitcnt lgkmcnt(0)
    v_mfma_f32_16x16x32_bf16 v[96:99], v[36:39], v[52:55], v[96:99]
    s_nop 7
    v_add_f32 v96, v96, v96 row_ror:8
    v_add_f32 v97, v97, v97 row_ror:8
    v_add_f32 v98, v98, v98 row_ror:8
    v_add_f32 v99, v99, v99 row_ror:8
    s_nop 0
    v_add_f32 v96, v96, v96 row_ror:4
    v_add_f32 v97, v97, v97 row_ror:4
    v_add_f32 v98, v98, v98 row_ror:4
    v_add_f32 v99, v99, v99 row_ror:4
    s_nop 0
    v_cvt_pk_bf16_f32 v100, v96, v97
    v_cvt_pk_bf16_f32 v101, v98, v99
    s_and_saveexec_b64 s[100:101], vcc
    buffer_store_dwordx4 v[100:103], v11, s[80:83], s92 offen sc1
    s_mov_b64 exec, s[100:101]
    s_barrier
    s_add_u32 m0, s29, 0
    s_add_u32 s31, s28, 0
    buffer_load_dwordx4 v6, s[36:39], s31 offen lds
    s_add_u32 m0, s29, 8320
    s_add_u32 s31, s28, 8192
    buffer_load_dwordx4 v6, s[36:39], s31 offen lds
    s_add_u32 m0, s29, 16640
    s_add_u32 s31, s28, 16384
    buffer_load_dwordx4 v6, s[36:39], s31 offen lds
    s_add_u32 m0, s29, 24960
    s_add_u32 s31, s28, 24576
    buffer_load_dwordx4 v6, s[36:39], s31 offen lds
    s_add_u32 m0, s29, 33280
    s_add_u32 s31, s28, 32768
    buffer_load_dwordx4 v6, s[36:39], s31 offen lds
    s_add_u32 m0, s29, 41600
    s_add_u32 s31, s28, 40960
    buffer_load_dwordx4 v6, s[36:39], s31 offen lds
    s_add_u32 m0, s29, 49920
    s_add_u32 s31, s28, 49152
    buffer_load_dwordx4 v6, s[36:39], s31 offen lds
    s_add_u32 m0, s29, 58240
    s_add_u32 s31, s28, 57344
    buffer_load_dwordx4 v6, s[36:39], s31 offen lds
    s_add_u32 m0, s29, 66560
    s_add_u32 s31, s28, 65536
    buffer_load_dwordx4 v6, s[36:39], s31 offen lds
    s_add_u32 m0, s29, 74880
    s_add_u32 s31, s28, 73728
    buffer_load_dwordx4 v6, s[36:39], s31 offen lds
    s_add_u32 m0, s29, 83200
    s_add_u32 s31, s28, 81920
    buffer_load_dwordx4 v6, s[36:39], s31 offen lds
    s_add_u32 m0, s29, 91520
    s_add_u32 s31, s28, 90112
    buffer_load_dwordx4 v6, s[36:39], s31 offen lds
    s_add_u32 m0, s29, 99840
    s_add_u32 s31, s28, 98304
    buffer_load_dwordx4 v6, s[36:39], s31 offen lds
    s_add_u32 m0, s29, 108160
    s_add_u32 s31, s28, 106496
    buffer_load_dwordx4 v6, s[36:39], s31 offen lds
    s_add_u32 m0, s29, 116480
    s_add_u32 s31, s28, 114688
    buffer_load_dwordx4 v6, s[36:39], s31 offen lds
    s_add_u32 m0, s29, 124800
    s_add_u32 s31, s28, 122880
    buffer_load_dwordx4 v6, s[36:39], s31 offen lds
    v_lshlrev_b32 v11, 4, v0
    s_lshr_b32 s93, s85, 1
    s_lshl_b32 s93, s93, 16
    s_lshl_b32 s94, s97, 15
    s_add_u32 s94, s94, s93
    s_add_u32 s94, s94, 131072
    s_lshl_b32 s30, s85, 5
    v_and_b32 v15, 7, v1
    v_lshlrev_b32 v15, 2, v15
    v_lshrrev_b32 v13, 7, v0
    v_mul_u32_u24 v13, 1040, v13
    v_and_b32 v14, 127, v0
    v_lshl_add_u32 v13, v14, 3, v13
    s_waitcnt vmcnt(8)
    s_add_u32 s93, s94, 0
    buffer_load_dwordx4 v[40:43], v11, s[80:83], s93 offen sc1
    s_add_u32 s93, s94, 8192
    buffer_load_dwordx4 v[44:47], v11, s[80:83], s93 offen sc1
    s_add_u32 s93, s94, 16384
    buffer_load_dwordx4 v[48:51], v11, s[80:83], s93 offen sc1
    s_add_u32 s93, s94, 24576
    buffer_load_dwordx4 v[52:55], v11, s[80:83], s93 offen sc1
    s_branch L_GATHER
L_STREAMER:
    s_lshl_b32 s92, s3, 5
    s_lshl_b32 s93, s84, 2
    s_add_u32 s92, s92, s93
    s_lshl_b32 s92, s92, 15
    s_lshl_b32 s94, s99, 8
    s_add_u32 s92, s92, s94
    s_lshl_b32 s93, s84, 12
    s_add_u32 s93, s93, 129536
    v_lshlrev_b32 v9, 5, v3
    v_xor_b32 v9, v9, v8
    v_xor_b32 v10, 128, v9
    s_add_u32 m0, s93, 0
    s_add_u32 s31, s92, 0
    buffer_load_dwordx4 v9, s[40:43], s31 offen lds
    s_add_u32 m0, s93, 1024
    s_add_u32 s31, s92, 32768
    buffer_load_dwordx4 v10, s[40:43], s31 offen lds
    s_add_u32 m0, s93, 2048
    s_add_u32 s31, s92, 65536
    buffer_load_dwordx4 v9, s[40:43], s31 offen lds
    s_add_u32 m0, s93, 3072
    s_add_u32 s31, s92, 98304
    buffer_load_dwordx4 v10, s[40:43], s31 offen lds
    s_lshl_b32 s30, s99, 2
    s_add_u32 s30, s30, s3
    s_lshl_b32 s30, s30, 11
    s_add_u32 s30, s30, 3145728
    s_lshl_b32 s93, s84, 8
    s_add_u32 s92, s30, s93
    v_lshlrev_b32 v10, 2, v1
    s_mov_b32 s25, s92
    s_add_u32 m0, s29, 0
    s_add_u32 s31, s28, 0
    buffer_load_dwordx4 v6, s[36:39], s31 offen lds
    s_add_u32 m0, s29, 8320
    s_add_u32 s31, s28, 8192
    buffer_load_dwordx4 v6, s[36:39], s31 offen lds
    s_add_u32 m0, s29, 16640
    s_add_u32 s31, s28, 16384
    buffer_load_dwordx4 v6, s[36:39], s31 offen lds
    s_add_u32 m0, s29, 24960
    s_add_u32 s31, s28, 24576
    buffer_load_dwordx4 v6, s[36:39], s31 offen lds
    v_lshrrev_b32 v11, 2, v2
    v_lshl_add_u32 v11, v3, 3, v11
    v_lshlrev_b32 v11, 8, v11
    v_and_b32 v13, 3, v2
    v_lshl_add_u32 v14, v13, 3, v11
    v_lshrrev_b32 v11, 2, v2
    v_xor_b32 v11, s84, v11
    v_lshl_add_u32 v14, v11, 5, v14
    v_add_u32 v14, 129536, v14
    v_xor_b32 v22, 128, v14
    v_mul_u32_u24 v13, 1040, v13
    v_lshl_add_u32 v13, v3, 4, v13
    s_lshl_b32 s92, s3, 8
    v_add_u32 v13, s92, v13
    v_lshlrev_b32 v15, 9, v2
    v_lshl_add_u32 v15, v3, 4, v15
    s_waitcnt vmcnt(8)
    v_readfirstlane_b32 s89, v20
    s_add_u32 s89, s89, 1
    s_cmp_ge_u32 s84, 4
    s_cbranch_scc1 L_ln1
    v_lshlrev_b32 v72, 16, v16
    v_and_b32 v73, 0xffff0000, v16
    v_lshlrev_b32 v74, 16, v17
    v_and_b32 v75, 0xffff0000, v17
    v_lshlrev_b32 v76, 16, v18
    v_and_b32 v77, 0xffff0000, v18
    v_lshlrev_b32 v78, 16, v19
    v_and_b32 v79, 0xffff0000, v19
    v_pk_add_f32 v[80:81], v[72:73], v[74:75]
    v_pk_add_f32 v[82:83], v[76:77], v[78:79]
    v_pk_add_f32 v[80:81], v[80:81], v[82:83]
    v_add_f32 v80, v80, v81
    s_nop 1
    v_add_f32 v80, v80, v80 row_ror:8
    s_nop 1
    v_add_f32 v80, v80, v80 row_ror:4
    s_nop 1
    v_add_f32 v80, v80, v80 row_ror:2
    s_nop 1
    v_add_f32 v80, v80, v80 row_ror:1
    v_mov_b32 v81, v80
    s_nop 1
    v_permlane16_swap_b32 v80, v81
    v_add_f32 v80, v80, v81
    v_mov_b32 v81, v80
    s_nop 1
    v_permlane32_swap_b32 v80, v81
    v_add_f32 v80, v80, v81
    v_mul_f32 v80, 0x3b000000, v80
    v_sub_f32 v84, v72, v80
    v_sub_f32 v85, v73, v80
    v_sub_f32 v86, v74, v80
    v_sub_f32 v87, v75, v80
    v_sub_f32 v88, v76, v80
    v_sub_f32 v89, v77, v80
    v_sub_f32 v90, v78, v80
    v_sub_f32 v91, v79, v80
    v_pk_mul_f32 v[82:83], v[84:85], v[84:85]
    v_pk_fma_f32 v[82:83], v[86:87], v[86:87], v[82:83]
    v_pk_fma_f32 v[82:83], v[88:89], v[88:89], v[82:83]
    v_pk_fma_f32 v[82:83], v[90:91], v[90:91], v[82:83]
    v_add_f32 v82, v82, v83
    s_nop 1
    v_add_f32 v82, v82, v82 row_ror:8
    s_nop 1
    v_add_f32 v82, v82, v82 row_ror:4
    s_nop 1
    v_add_f32 v82, v82, v82 row_ror:2
    s_nop 1
    v_add_f32 v82, v82, v82 row_ror:1
    v_mov_b32 v81, v82
    s_nop 1
    v_permlane16_swap_b32 v82, v81
    v_add_f32 v82, v82, v81
    v_mov_b32 v81, v82
    s_nop 1
    v_permlane32_swap_b32 v82, v81
    v_add_f32 v82, v82, v81
    v_mul_f32 v82, 0x3b000000, v82
    v_cvt_pk_bf16_f32 v83, v80, v82
    v_lshlrev_b32 v80, 16, v83
    v_and_b32 v82, 0xffff0000, v83
    v_add_f32 v82, 0x3727c5ac, v82
    v_cvt_pk_bf16_f32 v82, v82, v82
    v_lshlrev_b32 v82, 16, v82
    v_sqrt_f32 v82, v82
    v_sub_f32 v84, v72, v80
    v_sub_f32 v85, v73, v80
    v_sub_f32 v86, v74, v80
    v_sub_f32 v87, v75, v80
    v_sub_f32 v88, v76, v80
    v_sub_f32 v89, v77, v80
    v_sub_f32 v90, v78, v80
    v_sub_f32 v91, v79, v80
    v_cvt_pk_bf16_f32 v82, v82, v82
    v_lshlrev_b32 v82, 16, v82
    v_rcp_f32 v82, v82
    v_cvt_pk_bf16_f32 v92, v84, v85
    v_cvt_pk_bf16_f32 v93, v86, v87
    v_cvt_pk_bf16_f32 v94, v88, v89
    v_cvt_pk_bf16_f32 v95, v90, v91
    v_lshlrev_b32 v84, 16, v92
    v_and_b32 v85, 0xffff0000, v92
    v_lshlrev_b32 v86, 16, v93
    v_and_b32 v87, 0xffff0000, v93
    v_lshlrev_b32 v88, 16, v94
    v_and_b32 v89, 0xffff0000, v94
    v_lshlrev_b32 v90, 16, v95
    v_and_b32 v91, 0xffff0000, v95
    v_mul_f32 v84, v84, v82
    v_mul_f32 v85, v85, v82
    v_mul_f32 v86, v86, v82
    v_mul_f32 v87, v87, v82
    v_mul_f32 v88, v88, v82
    v_mul_f32 v89, v89, v82
    v_mul_f32 v90, v90, v82
    v_mul_f32 v91, v91, v82
    v_cvt_pk_bf16_f32 v92, v84, v85
    v_cvt_pk_bf16_f32 v93, v86, v87
    v_cvt_pk_bf16_f32 v94, v88, v89
    v_cvt_pk_bf16_f32 v95, v90, v91
    s_mul_i32 s92, s84, 1040
    v_add_u32 v11, s92, v6
    ds_write_b128 v11, v[92:95] offset:0
L_ln1:
    v_mov_b32 v102, s89
    v_mov_b32 v103, s89
    s_lshl_b32 s93, s84, 6
    s_add_u32 s92, s30, s93
    s_add_u32 s93, s92, 524288
    s_waitcnt vmcnt(4) lgkmcnt(0)
    s_barrier
    ds_read_b64_tr_b16 v[128:129], v14 offset:0
    ds_read_b64_tr_b16 v[130:131], v22 offset:1024
    ds_read_b128 v[132:135], v13 offset:0
    ds_read_b64_tr_b16 v[136:137], v14 offset:8192
    ds_read_b64_tr_b16 v[138:139], v22 offset:9216
    ds_read_b128 v[140:143], v13 offset:64
    ds_read_b64_tr_b16 v[144:145], v14 offset:16384
    ds_read_b64_tr_b16 v[146:147], v22 offset:17408
    ds_read_b128 v[148:151], v13 offset:128
    ds_read_b64_tr_b16 v[152:153], v14 offset:24576
    ds_read_b64_tr_b16 v[154:155], v22 offset:25600
    ds_read_b128 v[156:159], v13 offset:192
    v_cmp_gt_u32 vcc, 4, v2
    s_waitcnt lgkmcnt(9)
    v_mfma_f32_16x16x32_bf16 v[96:99], v[128:131], v[132:135], 0
    s_waitcnt lgkmcnt(6)
    v_mfma_f32_16x16x32_bf16 v[96:99], v[136:139], v[140:143], v[96:99]
    s_waitcnt lgkmcnt(3)
    v_mfma_f32_16x16x32_bf16 v[96:99], v[144:147], v[148:151], v[96:99]
    s_waitcnt lgkmcnt(0)
    v_mfma_f32_16x16x32_bf16 v[96:99], v[152:155], v[156:159], v[96:99]
    s_nop 7
    v_cvt_pk_bf16_f32 v100, v96, v97
    v_cvt_pk_bf16_f32 v101, v98, v99
    s_and_saveexec_b64 s[100:101], vcc
    buffer_store_dwordx4 v[100:103], v15, s[80:83], s92 offen
    buffer_store_dwordx4 v[100:103], v15, s[80:83], s93 offen sc1
    s_mov_b64 exec, s[100:101]
    s_barrier
    s_waitcnt lgkmcnt(0)
    s_min_u32 s31, s84, 6
    s_lshl_b32 s30, s31, 7
    v_add_u32 v9, s30, v1
    v_mul_u32_u24 v10, 2341, v9
    v_lshrrev_b32 v10, 16, v10
    v_mul_u32_u24 v13, 28, v10
    v_sub_u32 v13, v9, v13
    v_mul_u32_u24 v10, 3584, v10
    v_lshl_add_u32 v21, v13, 4, v10
    v_add_u32 v9, s30, v1
    v_add_u32 v9, 64, v9
    v_mul_u32_u24 v10, 2341, v9
    v_lshrrev_b32 v10, 16, v10
    v_mul_u32_u24 v13, 28, v10
    v_sub_u32 v13, v9, v13
    v_mul_u32_u24 v10, 3584, v10
    v_lshl_add_u32 v22, v13, 4, v10
    s_mul_i32 s92, s98, 114688
    s_mul_i32 s93, s85, 448
    s_add_u32 s92, s92, s93
    s_lshl_b32 s31, s31, 11
    s_add_u32 m0, s31, 13056
    s_nop 0
    buffer_load_dwordx4 v21, s[56:59], s92 offen lds
    s_add_u32 m0, s31, 14080
    s_nop 0
    buffer_load_dwordx4 v22, s[56:59], s92 offen lds
    s_add_u32 m0, s29, 33280
    s_add_u32 s31, s28, 32768
    buffer_load_dwordx4 v6, s[36:39], s31 offen lds
    s_add_u32 m0, s29, 41600
    s_add_u32 s31, s28, 40960
    buffer_load_dwordx4 v6, s[36:39], s31 offen lds
    s_add_u32 m0, s29, 49920
    s_add_u32 s31, s28, 49152
    buffer_load_dwordx4 v6, s[36:39], s31 offen lds
    s_add_u32 m0, s29, 58240
    s_add_u32 s31, s28, 57344
    buffer_load_dwordx4 v6, s[36:39], s31 offen lds
    s_add_u32 m0, s29, 66560
    s_add_u32 s31, s28, 65536
    buffer_load_dwordx4 v6, s[36:39], s31 offen lds
    s_add_u32 m0, s29, 74880
    s_add_u32 s31, s28, 73728
    buffer_load_dwordx4 v6, s[36:39], s31 offen lds
    s_add_u32 m0, s29, 83200
    s_add_u32 s31, s28, 81920
    buffer_load_dwordx4 v6, s[36:39], s31 offen lds
    s_add_u32 m0, s29, 91520
    s_add_u32 s31, s28, 90112
    buffer_load_dwordx4 v6, s[36:39], s31 offen lds
    s_add_u32 m0, s29, 99840
    s_add_u32 s31, s28, 98304
    buffer_load_dwordx4 v6, s[36:39], s31 offen lds
    s_add_u32 m0, s29, 108160
    s_add_u32 s31, s28, 106496
    buffer_load_dwordx4 v6, s[36:39], s31 offen lds
    s_add_u32 m0, s29, 116480
    s_add_u32 s31, s28, 114688
    buffer_load_dwordx4 v6, s[36:39], s31 offen lds
    s_add_u32 m0, s29, 124800
    s_add_u32 s31, s28, 122880
    buffer_load_dwordx4 v6, s[36:39], s31 offen lds
    v_and_b32 v9, 3, v2
    v_lshrrev_b32 v15, 2, v2
    v_lshl_add_u32 v15, v3, 3, v15
    v_mul_u32_u24 v15, 448, v15
    v_lshl_add_u32 v15, v9, 3, v15
    s_lshl_b32 s92, s84, 5
    v_add_u32 v15, s92, v15
    v_mul_u32_u24 v16, 1040, v9
    v_lshl_add_u32 v16, v3, 4, v16
    s_lshl_b32 s92, s98, 6
    v_add_u32 v16, s92, v16
    s_waitcnt vmcnt(12)
    s_barrier
    ds_read_b64_tr_b16 v[160:161], v15 offset:13056
    ds_read_b64_tr_b16 v[162:163], v15 offset:14848
    ds_read_b64_tr_b16 v[164:165], v15 offset:13312
    ds_read_b64_tr_b16 v[166:167], v15 offset:15104
    ds_read_b128 v[168:171], v16 offset:0
    v_lshlrev_b32 v17, 6, v2
    v_lshl_add_u32 v17, v3, 4, v17
    s_mul_i32 s92, s85, 14
    s_add_u32 s92, s92, s84
    s_lshl_b32 s92, s92, 12
    s_lshl_b32 s93, s98, 8
    s_add_u32 s92, s92, s93
    s_add_u32 s92, s92, 8388608
    s_add_u32 s93, s92, 32768
    v_mov_b32 v106, s89
    v_mov_b32 v107, s89
    v_mov_b32 v110, s89
    v_mov_b32 v111, s89
    s_waitcnt lgkmcnt(0)
    v_mfma_f32_16x16x32_bf16 v[112:115], v[160:163], v[168:171], 0
    v_mfma_f32_16x16x32_bf16 v[116:119], v[164:167], v[168:171], 0
    v_cmp_gt_u32 vcc, 4, v2
    s_nop 7
    v_cvt_pk_bf16_f32 v104, v112, v113
    v_cvt_pk_bf16_f32 v105, v114, v115
    v_cvt_pk_bf16_f32 v108, v116, v117
    v_cvt_pk_bf16_f32 v109, v118, v119
    s_and_saveexec_b64 s[100:101], vcc
    buffer_store_dwordx4 v[104:107], v17, s[80:83], s92 offen sc1
    s_cmp_ge_u32 s84, 6
    s_cbranch_scc1 L_nohx2
    buffer_store_dwordx4 v[108:111], v17, s[80:83], s93 offen sc1
L_nohx2:
    s_mov_b64 exec, s[100:101]
    s_barrier
    v_lshlrev_b32 v11, 4, v0
    s_lshr_b32 s93, s85, 1
    s_lshl_b32 s93, s93, 16
    s_lshl_b32 s94, s97, 15
    s_add_u32 s94, s94, s93
    s_add_u32 s94, s94, 131072
    s_lshl_b32 s30, s85, 5
    v_and_b32 v15, 7, v1
    v_lshlrev_b32 v15, 2, v15
    v_lshrrev_b32 v13, 7, v0
    v_mul_u32_u24 v13, 1040, v13
    v_and_b32 v14, 127, v0
    v_lshl_add_u32 v13, v14, 3, v13
    v_and_b32 v24, 3, v2
    v_lshlrev_b32 v21, 6, v24
    v_lshrrev_b32 v22, 2, v2
    v_lshl_add_u32 v21, v22, 8, v21
    v_lshl_add_u32 v21, v3, 4, v21
    s_min_u32 s27, s86, 13
    s_mul_i32 s31, s85, 14
    s_add_u32 s27, s27, s31
    s_lshl_b32 s26, s27, 12
    s_add_u32 s26, s26, 8388608
    v_lshlrev_b32 v23, 3, v3
    s_lshl_b32 s31, s27, 5
    s_waitcnt vmcnt(4)
    s_add_u32 s93, s94, 0
    buffer_load_dwordx4 v[40:43], v11, s[80:83], s93 offen sc1
    s_add_u32 s93, s94, 8192
    buffer_load_dwordx4 v[44:47], v11, s[80:83], s93 offen sc1
    s_add_u32 s93, s94, 16384
    buffer_load_dwordx4 v[48:51], v11, s[80:83], s93 offen sc1
    s_add_u32 s93, s94, 24576
    buffer_load_dwordx4 v[52:55], v11, s[80:83], s93 offen sc1
    buffer_load_dwordx2 v[232:233], v23, s[60:63], s31 offen
    buffer_load_dwordx4 v[216:219], v21, s[80:83], s26 offen offset:0 sc1
    buffer_load_dwordx4 v[220:223], v21, s[80:83], s26 offen offset:1024 sc1
    buffer_load_dwordx4 v[224:227], v21, s[80:83], s26 offen offset:2048 sc1
    buffer_load_dwordx4 v[228:231], v21, s[80:83], s26 offen offset:3072 sc1
    v_lshlrev_b32 v16, 2, v1
    s_lshl_b32 s76, s95, 11
    s_lshl_b32 s31, s84, 8
    s_add_u32 s76, s76, s31
    s_add_u32 s76, s76, 1048576
    s_lshl_b32 s77, s88, 4
    s_lshl_b32 s31, s84, 1
    s_add_u32 s77, s77, s31
    s_lshl_b32 s77, s77, 15
    s_lshl_b32 s78, s87, 8
    s_add_u32 s77, s77, s78
    s_add_u32 s78, s77, 32768
    v_lshrrev_b32 v17, 3, v1
    v_lshlrev_b32 v17, 10, v17
    v_and_b32 v19, 7, v1
    v_lshl_add_u32 v17, v19, 4, v17
    s_lshl_b32 s79, s87, 4
    s_add_u32 s79, s79, s31
    s_lshl_b32 s79, s79, 13
    s_lshl_b32 s90, s88, 7
    s_add_u32 s79, s79, s90
    s_add_u32 s90, s79, 8192
    s_min_u32 s27, s86, 13
    s_mul_i32 s31, s85, 14
    s_add_u32 s27, s27, s31
    s_lshl_b32 s91, s27, 14
    s_lshl_b32 s31, s84, 11
    s_add_u32 s91, s91, s31
    s_cmp_ge_u32 s86, 14
    s_cselect_b32 s91, 0x7ff00000, s91
    v_mov_b32 v18, v8
    s_waitcnt vmcnt(5)
    s_branch L_GATHER2
L_GATHER:
    v_lshlrev_b32 v16, 2, v1
    s_lshl_b32 s76, s95, 11
    s_lshl_b32 s31, s84, 8
    s_add_u32 s76, s76, s31
    s_add_u32 s76, s76, 1048576
    s_lshl_b32 s77, s88, 4
    s_lshl_b32 s31, s84, 1
    s_add_u32 s77, s77, s31
    s_lshl_b32 s77, s77, 15
    s_lshl_b32 s78, s87, 8
    s_add_u32 s77, s77, s78
    s_add_u32 s78, s77, 32768
    v_lshrrev_b32 v17, 3, v1
    v_lshlrev_b32 v17, 10, v17
    v_and_b32 v19, 7, v1
    v_lshl_add_u32 v17, v19, 4, v17
    s_lshl_b32 s79, s87, 4
    s_add_u32 s79, s79, s31
    s_lshl_b32 s79, s79, 13
    s_lshl_b32 s90, s88, 7
    s_add_u32 s79, s79, s90
    s_add_u32 s90, s79, 8192
    s_min_u32 s27, s86, 13
    s_mul_i32 s31, s85, 14
    s_add_u32 s27, s27, s31
    s_lshl_b32 s91, s27, 14
    s_lshl_b32 s31, s84, 11
    s_add_u32 s91, s91, s31
    s_cmp_ge_u32 s86, 14
    s_cselect_b32 s91, 0x7ff00000, s91
    v_mov_b32 v18, v8
    s_mov_b32 s96, 0
    s_mov_b32 s92, 0x80808080
    s_waitcnt vmcnt(0)
L_GATHER2:
    s_mov_b32 s96, 0
    s_mov_b32 s92, 0x80808080
pl_loop:
    s_mov_b32 s92, 0
    v_cmp_ne_u32 vcc, s89, v42
    v_cmp_ne_u32 s[100:101], s89, v43
    s_or_b64 vcc, vcc, s[100:101]
    s_cbranch_vccz pl_ok0
    s_add_u32 s93, s94, 0
    buffer_load_dwordx4 v[40:43], v11, s[80:83], s93 offen sc1
    s_mov_b32 s92, 1
pl_ok0:
    v_cmp_ne_u32 vcc, s89, v46
    v_cmp_ne_u32 s[100:101], s89, v47
    s_or_b64 vcc, vcc, s[100:101]
    s_cbranch_vccz pl_ok1
    s_add_u32 s93, s94, 8192
    buffer_load_dwordx4 v[44:47], v11, s[80:83], s93 offen sc1
    s_mov_b32 s92, 1
pl_ok1:
    v_cmp_ne_u32 vcc, s89, v50
    v_cmp_ne_u32 s[100:101], s89, v51
    s_or_b64 vcc, vcc, s[100:101]
    s_cbranch_vccz pl_ok2
    s_add_u32 s93, s94, 16384
    buffer_load_dwordx4 v[48:51], v11, s[80:83], s93 offen sc1
    s_mov_b32 s92, 1
pl_ok2:
    v_cmp_ne_u32 vcc, s89, v54
    v_cmp_ne_u32 s[100:101], s89, v55
    s_or_b64 vcc, vcc, s[100:101]
    s_cbranch_vccz pl_ok3
    s_add_u32 s93, s94, 24576
    buffer_load_dwordx4 v[52:55], v11, s[80:83], s93 offen sc1
    s_mov_b32 s92, 1
pl_ok3:
    s_cmp_eq_u32 s92, 0
    s_cbranch_scc1 pl_done
    s_add_u32 s96, s96, 1
    s_waitcnt vmcnt(0)
    s_cmp_lt_u32 s96, 200000
    s_cbranch_scc1 pl_loop
pl_done:
    ds_write_b64 v13, v[40:41] offset:13056
    ds_write_b64 v13, v[44:45] offset:17216
    ds_write_b64 v13, v[48:49] offset:21376
    ds_write_b64 v13, v[52:53] offset:25536
L_JOIN:
    v_and_b32 v8, 3, v2
    v_lshlrev_b32 v8, 2, v8
    v_lshrrev_b32 v9, 2, v2
    v_add_u32 v8, v8, v9
    s_lshl_b32 s92, s84, 4
    v_add_u32 v8, s92, v8
    v_mul_u32_u24 v8, 1040, v8
    v_lshl_add_u32 v8, v3, 8, v8
    v_add_u32 v8, 29696, v8
    v_mul_u32_u24 v9, 1040, v2
    v_lshl_add_u32 v9, v3, 8, v9
    v_add_u32 v9, 13056, v9
    s_waitcnt lgkmcnt(0)
    s_barrier
    buffer_load_dwordx4 v[192:195], v18, s[48:51], s77 offen
    buffer_load_dwordx4 v[196:199], v18, s[48:51], s78 offen
    buffer_load_dword v20, v16, s[80:83], s76 offen sc1
    buffer_load_dwordx4 v[200:203], v17, s[52:55], s79 offen
    buffer_load_dwordx4 v[204:207], v17, s[52:55], s90 offen
    buffer_load_dwordx4 v[208:211], v6, s[64:67], s91 offen offset:0
    buffer_load_dwordx4 v[212:215], v6, s[64:67], s91 offen offset:1024
    ds_read_b128 v[32:35], v8 offset:0
    ds_read_b128 v[36:39], v9 offset:0
    ds_read_b128 v[40:43], v8 offset:16
    ds_read_b128 v[44:47], v9 offset:16
    ds_read_b128 v[48:51], v8 offset:32
    ds_read_b128 v[52:55], v9 offset:32
    ds_read_b128 v[56:59], v8 offset:48
    ds_read_b128 v[60:63], v9 offset:48
    ds_read_b128 v[64:67], v8 offset:64
    ds_read_b128 v[68:71], v9 offset:64
    ds_read_b128 v[72:75], v8 offset:80
    ds_read_b128 v[76:79], v9 offset:80
    ds_read_b128 v[80:83], v8 offset:96
    ds_read_b128 v[84:87], v9 offset:96
    s_waitcnt lgkmcnt(12)
    v_mfma_f32_16x16x32_bf16 v[96:99], v[32:35], v[36:39], 0
    ds_read_b128 v[88:91], v8 offset:112
    ds_read_b128 v[92:95], v9 offset:112
    s_waitcnt lgkmcnt(12)
    v_mfma_f32_16x16x32_bf16 v[96:99], v[40:43], v[44:47], v[96:99]
    ds_read_b128 v[32:35], v8 offset:128
    ds_read_b128 v[36:39], v9 offset:128
    s_waitcnt lgkmcnt(12)
    v_mfma_f32_16x16x32_bf16 v[96:99], v[48:51], v[52:55], v[96:99]
    ds_read_b128 v[40:43], v8 offset:144
    ds_read_b128 v[44:47], v9 offset:144
    s_waitcnt lgkmcnt(12)
    v_mfma_f32_16x16x32_bf16 v[96:99], v[56:59], v[60:63], v[96:99]
    ds_read_b128 v[48:51], v8 offset:160
    ds_read_b128 v[52:55], v9 offset:160
    s_waitcnt lgkmcnt(12)
    v_mfma_f32_16x16x32_bf16 v[96:99], v[64:67], v[68:71], v[96:99]
    ds_read_b128 v[56:59], v8 offset:176
    ds_read_b128 v[60:63], v9 offset:176
    s_waitcnt lgkmcnt(12)
    v_mfma_f32_16x16x32_bf16 v[96:99], v[72:75], v[76:79], v[96:99]
    ds_read_b128 v[64:67], v8 offset:192
    ds_read_b128 v[68:71], v9 offset:192
    s_waitcnt lgkmcnt(12)
    v_mfma_f32_16x16x32_bf16 v[96:99], v[80:83], v[84:87], v[96:99]
    ds_read_b128 v[72:75], v8 offset:208
    ds_read_b128 v[76:79], v9 offset:208
    s_waitcnt lgkmcnt(12)
    v_mfma_f32_16x16x32_bf16 v[96:99], v[88:91], v[92:95], v[96:99]
    ds_read_b128 v[80:83], v8 offset:224
    ds_read_b128 v[84:87], v9 offset:224
    s_waitcnt lgkmcnt(12)
    v_mfma_f32_16x16x32_bf16 v[96:99], v[32:35], v[36:39], v[96:99]
    ds_read_b128 v[88:91], v8 offset:240
    ds_read_b128 v[92:95], v9 offset:240
    s_waitcnt lgkmcnt(12)
    v_mfma_f32_16x16x32_bf16 v[96:99], v[40:43], v[44:47], v[96:99]
    s_waitcnt lgkmcnt(10)
    v_mfma_f32_16x16x32_bf16 v[96:99], v[48:51], v[52:55], v[96:99]
    s_waitcnt lgkmcnt(8)
    v_mfma_f32_16x16x32_bf16 v[96:99], v[56:59], v[60:63], v[96:99]
    s_waitcnt lgkmcnt(6)
    v_mfma_f32_16x16x32_bf16 v[96:99], v[64:67], v[68:71], v[96:99]
    s_waitcnt lgkmcnt(4)
    v_mfma_f32_16x16x32_bf16 v[96:99], v[72:75], v[76:79], v[96:99]
    s_waitcnt lgkmcnt(2)
    v_mfma_f32_16x16x32_bf16 v[96:99], v[80:83], v[84:87], v[96:99]
    s_waitcnt lgkmcnt(0)
    v_mfma_f32_16x16x32_bf16 v[96:99], v[88:91], v[92:95], v[96:99]
    v_lshrrev_b32 v10, 1, v3
    v_lshlrev_b32 v10, 4, v10
    v_lshrrev_b32 v11, 2, v2
    v_lshl_add_u32 v10, v11, 2, v10
    v_and_b32 v11, 1, v3
    v_lshl_add_u32 v10, v11, 1, v10
    v_mul_u32_u24 v10, 1040, v10
    v_and_b32 v11, 3, v2
    v_lshl_add_u32 v10, v11, 3, v10
    s_lshl_b32 s92, s84, 7
    s_add_u32 s92, s92, 29696
    v_add_u32 v10, s92, v10
    v_add_u32 v14, 66560, v10
    s_mov_b32 s92, 0x3e028f33
    v_mul_f32 v96, s92, v96
    v_mul_f32 v97, s92, v97
    v_mul_f32 v98, s92, v98
    v_mul_f32 v99, s92, v99
    v_max_f32 v100, v96, v97
    v_max3_f32 v100, v100, v98, v99
    v_mov_b32 v101, v100
    s_nop 1
    v_permlane16_swap_b32 v100, v101
    v_max_f32 v100, v100, v101
    v_mov_b32 v101, v100
    s_nop 1
    v_permlane32_swap_b32 v100, v101
    v_max_f32 v100, v100, v101
    v_lshlrev_b32 v11, 5, v2
    s_lshl_b32 s92, s84, 2
    v_add_u32 v13, s92, v11
    ds_write_b32 v13, v100 offset:8704
    ds_read_b64_tr_b16 v[128:129], v10 offset:0
    ds_read_b64_tr_b16 v[130:131], v10 offset:1040
    ds_read_b64_tr_b16 v[132:133], v10 offset:32
    ds_read_b64_tr_b16 v[134:135], v10 offset:1072
    ds_read_b64_tr_b16 v[136:137], v10 offset:64
    ds_read_b64_tr_b16 v[138:139], v10 offset:1104
    ds_read_b64_tr_b16 v[140:141], v10 offset:96
    ds_read_b64_tr_b16 v[142:143], v10 offset:1136
    s_waitcnt lgkmcnt(8)
    s_barrier
    ds_read_b128 v[32:35], v11 offset:8704
    ds_read_b128 v[36:39], v11 offset:8720
    ds_read_b64_tr_b16 v[144:145], v10 offset:33280
    ds_read_b64_tr_b16 v[146:147], v10 offset:34320
    ds_read_b64_tr_b16 v[148:149], v10 offset:33312
    ds_read_b64_tr_b16 v[150:151], v10 offset:34352
    ds_read_b64_tr_b16 v[152:153], v10 offset:33344
    ds_read_b64_tr_b16 v[154:155], v10 offset:34384
    ds_read_b64_tr_b16 v[156:157], v10 offset:33376
    ds_read_b64_tr_b16 v[158:159], v10 offset:34416
    s_waitcnt lgkmcnt(8)
    v_max3_f32 v100, v32, v33, v34
    v_max3_f32 v100, v100, v35, v36
    v_max3_f32 v100, v100, v37, v38
    v_max_f32 v100, v100, v39
    v_sub_f32 v96, v96, v100
    v_sub_f32 v97, v97, v100
    v_sub_f32 v98, v98, v100
    v_sub_f32 v99, v99, v100
    v_exp_f32 v96, v96
    v_exp_f32 v97, v97
    v_exp_f32 v98, v98
    v_exp_f32 v99, v99
    v_mul_u32_u24 v5, 272, v2
    s_lshl_b32 s92, s84, 5
    v_lshl_add_u32 v15, v3, 3, v5
    v_add_u32 v15, s92, v15
    v_cvt_pk_bf16_f32 v104, v96, v97
    v_cvt_pk_bf16_f32 v105, v98, v99
    ds_write_b64 v15, v[104:105] offset:4352
    v_add_f32 v101, v96, v97
    v_add_f32 v102, v98, v99
    v_add_f32 v101, v101, v102
    v_mov_b32 v102, v101
    s_nop 1
    v_permlane16_swap_b32 v101, v102
    v_add_f32 v101, v101, v102
    v_mov_b32 v102, v101
    s_nop 1
    v_permlane32_swap_b32 v101, v102
    v_add_f32 v101, v101, v102
    ds_write_b32 v13, v101 offset:9216
    v_lshl_add_u32 v5, v3, 4, v5
    s_waitcnt lgkmcnt(0)
    s_barrier
    ds_read_b128 v[32:35], v5 offset:4352
    ds_read_b128 v[36:39], v5 offset:4416
    ds_read_b128 v[40:43], v5 offset:4480
    ds_read_b128 v[44:47], v5 offset:4544
    ds_read_b64_tr_b16 v[160:161], v14 offset:0
    ds_read_b64_tr_b16 v[162:163], v14 offset:1040
    ds_read_b64_tr_b16 v[164:165], v14 offset:32
    ds_read_b64_tr_b16 v[166:167], v14 offset:1072
    ds_read_b64_tr_b16 v[168:169], v14 offset:64
    ds_read_b64_tr_b16 v[170:171], v14 offset:1104
    ds_read_b64_tr_b16 v[172:173], v14 offset:96
    ds_read_b64_tr_b16 v[174:175], v14 offset:1136
    s_waitcnt lgkmcnt(11)
    v_mfma_f32_16x16x32_bf16 v[108:111], v[32:35], v[128:131], 0
    v_mfma_f32_16x16x32_bf16 v[112:115], v[32:35], v[132:135], 0
    v_mfma_f32_16x16x32_bf16 v[116:119], v[32:35], v[136:139], 0
    v_mfma_f32_16x16x32_bf16 v[120:123], v[32:35], v[140:143], 0
    s_waitcnt lgkmcnt(8)
    ds_read_b64_tr_b16 v[176:177], v14 offset:33280
    ds_read_b64_tr_b16 v[178:179], v14 offset:34320
    ds_read_b64_tr_b16 v[180:181], v14 offset:33312
    ds_read_b64_tr_b16 v[182:183], v14 offset:34352
    ds_read_b64_tr_b16 v[184:185], v14 offset:33344
    ds_read_b64_tr_b16 v[186:187], v14 offset:34384
    ds_read_b64_tr_b16 v[188:189], v14 offset:33376
    ds_read_b64_tr_b16 v[190:191], v14 offset:34416
    v_mfma_f32_16x16x32_bf16 v[108:111], v[36:39], v[144:147], v[108:111]
    v_mfma_f32_16x16x32_bf16 v[112:115], v[36:39], v[148:151], v[112:115]
    v_mfma_f32_16x16x32_bf16 v[116:119], v[36:39], v[152:155], v[116:119]
    v_mfma_f32_16x16x32_bf16 v[120:123], v[36:39], v[156:159], v[120:123]
    v_lshlrev_b32 v11, 19, v3
    v_lshl_add_u32 v11, v2, 3, v11
    s_lshl_b32 s92, s97, 21
    s_lshl_b32 s93, s84, 14
    s_add_u32 s92, s92, s93
    s_lshl_b32 s30, s85, 4
    s_add_u32 s30, s30, s98
    s_lshl_b32 s93, s30, 7
    s_add_u32 s92, s92, s93
    s_add_u32 s92, s92, 4194304
    s_waitcnt lgkmcnt(8)
    v_mfma_f32_16x16x32_bf16 v[108:111], v[40:43], v[160:163], v[108:111]
    v_mfma_f32_16x16x32_bf16 v[112:115], v[40:43], v[164:167], v[112:115]
    v_mfma_f32_16x16x32_bf16 v[116:119], v[40:43], v[168:171], v[116:119]
    v_mfma_f32_16x16x32_bf16 v[120:123], v[40:43], v[172:175], v[120:123]
    s_waitcnt lgkmcnt(0)
    v_mfma_f32_16x16x32_bf16 v[108:111], v[44:47], v[176:179], v[108:111]
    v_mfma_f32_16x16x32_bf16 v[112:115], v[44:47], v[180:183], v[112:115]
    v_mfma_f32_16x16x32_bf16 v[116:119], v[44:47], v[184:187], v[116:119]
    v_mfma_f32_16x16x32_bf16 v[120:123], v[44:47], v[188:191], v[120:123]
    v_and_b32 v40, 1, v2
    v_lshlrev_b32 v40, 2, v40
    v_lshrrev_b32 v41, v40, s89
    v_and_b32 v40, 1, v41
    v_bfe_u32 v42, v41, 1, 1
    v_lshl_or_b32 v40, v42, 16, v40
    v_bfe_u32 v42, v41, 2, 1
    v_bfe_u32 v41, v41, 3, 1
    v_lshl_or_b32 v41, v41, 16, v42
    s_mov_b32 s31, 0xfffefffe
    v_cvt_pk_bf16_f32 v32, v108, v112
    v_cvt_pk_bf16_f32 v33, v116, v120
    v_cvt_pk_bf16_f32 v34, v109, v113
    v_cvt_pk_bf16_f32 v35, v117, v121
    v_cvt_pk_bf16_f32 v36, v110, v114
    v_cvt_pk_bf16_f32 v37, v118, v122
    v_cvt_pk_bf16_f32 v38, v111, v115
    v_cvt_pk_bf16_f32 v39, v119, v123
    v_and_or_b32 v32, v32, s31, v40
    v_and_or_b32 v33, v33, s31, v41
    v_and_or_b32 v34, v34, s31, v40
    v_and_or_b32 v35, v35, s31, v41
    v_and_or_b32 v36, v36, s31, v40
    v_and_or_b32 v37, v37, s31, v41
    v_and_or_b32 v38, v38, s31, v40
    v_and_or_b32 v39, v39, s31, v41
    s_add_u32 s93, s92, 0
    buffer_store_dwordx2 v[32:33], v11, s[80:83], s93 offen sc1
    s_add_u32 s93, s92, 131072
    buffer_store_dwordx2 v[34:35], v11, s[80:83], s93 offen sc1
    s_add_u32 s93, s92, 262144
    buffer_store_dwordx2 v[36:37], v11, s[80:83], s93 offen sc1
    s_add_u32 s93, s92, 393216
    buffer_store_dwordx2 v[38:39], v11, s[80:83], s93 offen sc1
    v_lshlrev_b32 v11, 5, v2
    ds_read_b128 v[40:43], v11 offset:9216
    ds_read_b128 v[44:47], v11 offset:9232
    v_lshlrev_b32 v11, 14, v2
    s_lshl_b32 s92, s97, 18
    s_lshl_b32 s93, s84, 11
    s_add_u32 s92, s92, s93
    s_lshl_b32 s93, s30, 4
    s_add_u32 s92, s92, s93
    s_add_u32 s92, s92, 10485760
    v_mov_b32 v102, s89
    v_mov_b32 v103, s89
    v_cmp_gt_u32 vcc, 16, v1
    s_waitcnt lgkmcnt(0)
    v_pk_add_f32 v[40:41], v[40:41], v[42:43]
    v_pk_add_f32 v[44:45], v[44:45], v[46:47]
    v_pk_add_f32 v[40:41], v[40:41], v[44:45]
    v_add_f32 v101, v40, v41
    s_and_saveexec_b64 s[100:101], vcc
    buffer_store_dwordx4 v[100:103], v11, s[80:83], s92 offen sc1
    s_mov_b64 exec, s[100:101]
    s_barrier
    s_lshl_b32 s93, s84, 11
    s_add_u32 s93, s93, 29696
    s_lshr_b32 s31, s84, 1
    s_lshl_b32 s31, s31, 6
    v_lshrrev_b32 v14, 1, v3
    v_lshlrev_b32 v14, 5, v14
    v_or_b32 v14, s31, v14
    v_xor_b32 v14, v14, v6
    v_add_u32 v14, s93, v14
    v_bfe_u32 v15, v1, 3, 2
    v_lshlrev_b32 v15, 5, v15
    v_xor_b32 v15, v15, v6
    s_mul_i32 s93, s84, 2304
    s_add_u32 s93, s93, 29696
    v_add_u32 v15, s93, v15
    s_lshl_b32 s93, s84, 11
    s_add_u32 s93, s93, 29696
    v_add_u32 v13, s93, v6
    s_waitcnt vmcnt(5)
    ds_write_b128 v14, v[192:195] offset:0
    ds_write_b128 v14, v[196:199] offset:1024
    ds_write_b128 v15, v[200:203] offset:16384
    ds_write_b128 v15, v[204:207] offset:17536
    ds_write_b128 v13, v[208:211] offset:49152
    ds_write_b128 v13, v[212:215] offset:50176
    s_waitcnt lgkmcnt(0)
    s_barrier
    v_lshrrev_b32 v19, 3, v1
    v_lshlrev_b32 v19, 4, v19
    s_lshl_b32 s79, s95, 11
    s_lshr_b32 s93, s84, 1
    s_lshl_b32 s93, s93, 9
    s_add_u32 s79, s79, s93
    s_add_u32 s79, s79, 10485760
    s_lshl_b32 s78, s95, 14
    s_lshl_b32 s93, s84, 11
    s_add_u32 s78, s78, s93
    s_add_u32 s78, s78, 4194304
    buffer_load_dwordx4 v[32:35], v19, s[80:83], s79 offen offset:0 sc1
    buffer_load_dwordx4 v[36:39], v19, s[80:83], s79 offen offset:128 sc1
    buffer_load_dwordx4 v[40:43], v19, s[80:83], s79 offen offset:256 sc1
    buffer_load_dwordx4 v[44:47], v19, s[80:83], s79 offen offset:384 sc1
    v_lshrrev_b32 v10, 2, v2
    v_lshlrev_b32 v11, 4, v10
    v_lshl_add_u32 v11, v3, 1, v11
    v_lshlrev_b32 v11, 8, v11
    v_and_b32 v9, 3, v2
    v_lshl_add_u32 v11, v9, 3, v11
    v_and_b32 v14, 1, v3
    v_lshl_add_u32 v10, v10, 1, v14
    v_xor_b32 v10, s84, v10
    v_lshl_add_u32 v11, v10, 5, v11
    v_add_u32 v11, 29696, v11
    ds_read_b64_tr_b16 v[128:129], v11 offset:0
    ds_read_b64_tr_b16 v[130:131], v11 offset:256
    ds_read_b64_tr_b16 v[132:133], v11 offset:2048
    ds_read_b64_tr_b16 v[134:135], v11 offset:2304
    v_and_b32 v9, 3, v2
    s_cmp_ge_u32 s86, 14
    s_cbranch_scc1 L_noh
    v_lshrrev_b32 v17, 2, v2
    v_lshl_add_u32 v10, v3, 2, v17
    v_lshlrev_b32 v10, 10, v10
    v_lshl_add_u32 v10, v9, 3, v10
    s_lshl_b32 s93, s84, 7
    s_add_u32 s93, s93, 29696
    v_add_u32 v10, s93, v10
    ds_read_b64_tr_b16 v[176:177], v10 offset:49152
    ds_read_b64_tr_b16 v[178:179], v10 offset:49184
    ds_read_b64_tr_b16 v[180:181], v10 offset:49216
    ds_read_b64_tr_b16 v[182:183], v10 offset:49248
    v_mul_u32_u24 v17, 28672, v2
    v_lshl_add_u32 v17, v3, 4, v17
    s_mul_i32 s92, s84, 114688
    s_lshl_b32 s93, s27, 8
    s_add_u32 s92, s92, s93
    s_add_u32 s92, s92, 2097152
    v_cmp_ne_u32 vcc, s89, v218
    v_cmp_ne_u32 s[100:101], s89, v222
    s_or_b64 vcc, vcc, s[100:101]
    v_cmp_ne_u32 s[100:101], s89, v226
    s_or_b64 vcc, vcc, s[100:101]
    v_cmp_ne_u32 s[100:101], s89, v230
    s_or_b64 vcc, vcc, s[100:101]
    v_cmp_ne_u32 s[100:101], s89, v219
    s_or_b64 vcc, vcc, s[100:101]
    v_cmp_ne_u32 s[100:101], s89, v223
    s_or_b64 vcc, vcc, s[100:101]
    v_cmp_ne_u32 s[100:101], s89, v227
    s_or_b64 vcc, vcc, s[100:101]
    v_cmp_ne_u32 s[100:101], s89, v231
    s_or_b64 vcc, vcc, s[100:101]
    s_cbranch_vccz ph_done
    s_mov_b32 s96, 0
ph_loop:
    buffer_load_dwordx4 v[216:219], v21, s[80:83], s26 offen offset:0 sc1
    buffer_load_dwordx4 v[220:223], v21, s[80:83], s26 offen offset:1024 sc1
    buffer_load_dwordx4 v[224:227], v21, s[80:83], s26 offen offset:2048 sc1
    buffer_load_dwordx4 v[228:231], v21, s[80:83], s26 offen offset:3072 sc1
    s_waitcnt vmcnt(0)
    v_cmp_ne_u32 vcc, s89, v218
    v_cmp_ne_u32 s[100:101], s89, v222
    s_or_b64 vcc, vcc, s[100:101]
    v_cmp_ne_u32 s[100:101], s89, v226
    s_or_b64 vcc, vcc, s[100:101]
    v_cmp_ne_u32 s[100:101], s89, v230
    s_or_b64 vcc, vcc, s[100:101]
    v_cmp_ne_u32 s[100:101], s89, v219
    s_or_b64 vcc, vcc, s[100:101]
    v_cmp_ne_u32 s[100:101], s89, v223
    s_or_b64 vcc, vcc, s[100:101]
    v_cmp_ne_u32 s[100:101], s89, v227
    s_or_b64 vcc, vcc, s[100:101]
    v_cmp_ne_u32 s[100:101], s89, v231
    s_or_b64 vcc, vcc, s[100:101]
    s_cbranch_vccz ph_done
    s_add_u32 s96, s96, 1
    s_sleep 2
    s_cmp_lt_u32 s96, 200000
    s_cbranch_scc1 ph_loop
ph_done:
    v_lshlrev_b32 v96, 16, v216
    v_and_b32 v97, 0xffff0000, v216
    v_lshlrev_b32 v98, 16, v217
    v_and_b32 v99, 0xffff0000, v217
    v_lshlrev_b32 v104, 16, v220
    v_and_b32 v105, 0xffff0000, v220
    v_pk_add_f32 v[96:97], v[96:97], v[104:105]
    v_lshlrev_b32 v104, 16, v221
    v_and_b32 v105, 0xffff0000, v221
    v_pk_add_f32 v[98:99], v[98:99], v[104:105]
    v_lshlrev_b32 v104, 16, v224
    v_and_b32 v105, 0xffff0000, v224
    v_pk_add_f32 v[96:97], v[96:97], v[104:105]
    v_lshlrev_b32 v104, 16, v225
    v_and_b32 v105, 0xffff0000, v225
    v_pk_add_f32 v[98:99], v[98:99], v[104:105]
    v_lshlrev_b32 v104, 16, v228
    v_and_b32 v105, 0xffff0000, v228
    v_pk_add_f32 v[96:97], v[96:97], v[104:105]
    v_lshlrev_b32 v104, 16, v229
    v_and_b32 v105, 0xffff0000, v229
    v_pk_add_f32 v[98:99], v[98:99], v[104:105]
    v_lshlrev_b32 v62, 16, v232
    v_and_b32 v63, 0xffff0000, v232
    v_lshlrev_b32 v64, 16, v233
    v_and_b32 v65, 0xffff0000, v233
    v_add_f32 v96, v96, v96 row_ror:8
    v_add_f32 v97, v97, v97 row_ror:8
    v_add_f32 v98, v98, v98 row_ror:8
    v_add_f32 v99, v99, v99 row_ror:8
    s_nop 0
    v_add_f32 v96, v96, v96 row_ror:4
    v_add_f32 v97, v97, v97 row_ror:4
    v_add_f32 v98, v98, v98 row_ror:4
    v_add_f32 v99, v99, v99 row_ror:4
    s_nop 0
    v_pk_add_f32 v[62:63], v[62:63], v[96:97]
    v_pk_add_f32 v[64:65], v[64:65], v[98:99]
    v_max_f32 v62, 0, v62
    v_max_f32 v63, 0, v63
    v_max_f32 v64, 0, v64
    v_max_f32 v65, 0, v65
    v_pk_mul_f32 v[62:63], v[62:63], v[62:63]
    v_pk_mul_f32 v[64:65], v[64:65], v[64:65]
    v_cvt_pk_bf16_f32 v28, v62, v63
    v_cvt_pk_bf16_f32 v29, v64, v65
    v_cmp_gt_u32 vcc, 4, v2
    s_waitcnt lgkmcnt(0)
    v_mfma_f32_16x16x16_bf16 v[152:155], v[176:177], v[28:29], 0
    v_mfma_f32_16x16x16_bf16 v[156:159], v[178:179], v[28:29], 0
    v_mfma_f32_16x16x16_bf16 v[160:163], v[180:181], v[28:29], 0
    v_mfma_f32_16x16x16_bf16 v[164:167], v[182:183], v[28:29], 0
    s_nop 6
    v_cvt_pk_bf16_f32 v152, v152, v153
    v_cvt_pk_bf16_f32 v153, v154, v155
    v_mov_b32 v154, s89
    v_mov_b32 v155, s89
    v_cvt_pk_bf16_f32 v156, v156, v157
    v_cvt_pk_bf16_f32 v157, v158, v159
    v_mov_b32 v158, s89
    v_mov_b32 v159, s89
    v_cvt_pk_bf16_f32 v160, v160, v161
    v_cvt_pk_bf16_f32 v161, v162, v163
    v_mov_b32 v162, s89
    v_mov_b32 v163, s89
    v_cvt_pk_bf16_f32 v164, v164, v165
    v_cvt_pk_bf16_f32 v165, v166, v167
    v_mov_b32 v166, s89
    v_mov_b32 v167, s89
    s_and_saveexec_b64 s[100:101], vcc
    buffer_store_dwordx4 v[152:155], v17, s[80:83], s92 offen offset:0 sc1
    buffer_store_dwordx4 v[156:159], v17, s[80:83], s92 offen offset:64 sc1
    buffer_store_dwordx4 v[160:163], v17, s[80:83], s92 offen offset:128 sc1
    buffer_store_dwordx4 v[164:167], v17, s[80:83], s92 offen offset:192 sc1
    s_mov_b64 exec, s[100:101]
L_noh:
    s_cmp_lt_u32 s86, 28
    s_cbranch_scc1 L_nob2
    v_lshlrev_b32 v13, 3, v2
    s_lshl_b32 s93, s85, 7
    buffer_load_dwordx2 v[64:65], v13, s[68:71], s93 offen
    s_sub_u32 s94, s86, 28
    s_lshl_b32 s94, s94, 10
    s_add_u32 s94, s94, s93
    buffer_load_dwordx2 v[66:67], v13, s[32:35], s94 offen
L_nob2:
    s_cmp_lt_u32 s86, 14
    s_cbranch_scc1 L_mw4
    s_cmp_ge_u32 s86, 28
    s_cbranch_scc1 L_mw2
    s_waitcnt vmcnt(0)
L_mw2:
    s_waitcnt vmcnt(2)
L_mw4:
    s_waitcnt vmcnt(4)
    v_cmp_ne_u32 vcc, s89, v34
    v_cmp_ne_u32 s[100:101], s89, v38
    s_or_b64 vcc, vcc, s[100:101]
    v_cmp_ne_u32 s[100:101], s89, v42
    s_or_b64 vcc, vcc, s[100:101]
    v_cmp_ne_u32 s[100:101], s89, v46
    s_or_b64 vcc, vcc, s[100:101]
    v_cmp_ne_u32 s[100:101], s89, v35
    s_or_b64 vcc, vcc, s[100:101]
    v_cmp_ne_u32 s[100:101], s89, v39
    s_or_b64 vcc, vcc, s[100:101]
    v_cmp_ne_u32 s[100:101], s89, v43
    s_or_b64 vcc, vcc, s[100:101]
    v_cmp_ne_u32 s[100:101], s89, v47
    s_or_b64 vcc, vcc, s[100:101]
    s_cbranch_vccz pm_done
    s_mov_b32 s96, 0
pm_loop:
    buffer_load_dwordx4 v[32:35], v19, s[80:83], s79 offen offset:0 sc1
    buffer_load_dwordx4 v[36:39], v19, s[80:83], s79 offen offset:128 sc1
    buffer_load_dwordx4 v[40:43], v19, s[80:83], s79 offen offset:256 sc1
    buffer_load_dwordx4 v[44:47], v19, s[80:83], s79 offen offset:384 sc1
    s_waitcnt vmcnt(0)
    v_cmp_ne_u32 vcc, s89, v34
    v_cmp_ne_u32 s[100:101], s89, v38
    s_or_b64 vcc, vcc, s[100:101]
    v_cmp_ne_u32 s[100:101], s89, v42
    s_or_b64 vcc, vcc, s[100:101]
    v_cmp_ne_u32 s[100:101], s89, v46
    s_or_b64 vcc, vcc, s[100:101]
    v_cmp_ne_u32 s[100:101], s89, v35
    s_or_b64 vcc, vcc, s[100:101]
    v_cmp_ne_u32 s[100:101], s89, v39
    s_or_b64 vcc, vcc, s[100:101]
    v_cmp_ne_u32 s[100:101], s89, v43
    s_or_b64 vcc, vcc, s[100:101]
    v_cmp_ne_u32 s[100:101], s89, v47
    s_or_b64 vcc, vcc, s[100:101]
    s_cbranch_vccz pm_done
    s_add_u32 s96, s96, 1
    s_sleep 3
    s_cmp_lt_u32 s96, 200000
    s_cbranch_scc1 pm_loop
pm_done:
    buffer_load_dwordx4 v[48:51], v6, s[80:83], s78 offen offset:0 sc1 nt
    buffer_load_dwordx4 v[52:55], v6, s[80:83], s78 offen offset:1024 sc1 nt
    v_max_f32 v56, v32, v36
    v_max3_f32 v56, v56, v40, v44
    s_nop 1
    v_max_f32 v56, v56, v56 row_ror:8
    v_mov_b32 v57, v56
    s_nop 1
    v_permlane16_swap_b32 v56, v57
    v_max_f32 v56, v56, v57
    v_mov_b32 v57, v56
    s_nop 1
    v_permlane32_swap_b32 v56, v57
    v_max_f32 v56, v56, v57
    v_sub_f32 v32, v32, v56
    v_sub_f32 v36, v36, v56
    v_sub_f32 v40, v40, v56
    v_sub_f32 v44, v44, v56
    v_exp_f32 v32, v32
    v_exp_f32 v36, v36
    v_exp_f32 v40, v40
    v_exp_f32 v44, v44
    s_nop 0
    v_mul_f32 v57, v32, v33
    v_fmac_f32 v57, v36, v37
    v_fmac_f32 v57, v40, v41
    v_fmac_f32 v57, v44, v45
    s_nop 1
    v_add_f32 v57, v57, v57 row_ror:8
    v_mov_b32 v58, v57
    s_nop 1
    v_permlane16_swap_b32 v57, v58
    v_add_f32 v57, v57, v58
    v_mov_b32 v58, v57
    s_nop 1
    v_permlane32_swap_b32 v57, v58
    v_add_f32 v57, v57, v58
    v_rcp_f32 v58, v57
    s_bitcmp1_b32 s84, 0
    s_cselect_b64 s[100:101], -1, 0
    v_cndmask_b32 v32, v32, v40, s[100:101]
    v_cndmask_b32 v36, v36, v44, s[100:101]
    v_mul_f32 v32, v32, v58
    v_mul_f32 v36, v36, v58
    s_mul_i32 s93, s84, 144
    v_lshlrev_b32 v13, 4, v1
    v_add_u32 v13, s93, v13
    s_lshr_b32 s76, s89, 0
    s_and_b32 s31, s76, 2
    s_lshl_b32 s31, s31, 15
    s_and_b32 s76, s76, 1
    s_or_b32 s76, s76, s31
    s_lshr_b32 s77, s89, 2
    s_and_b32 s31, s77, 2
    s_lshl_b32 s31, s31, 15
    s_and_b32 s77, s77, 1
    s_or_b32 s77, s77, s31
    s_lshr_b32 s90, s89, 4
    s_and_b32 s31, s90, 2
    s_lshl_b32 s31, s31, 15
    s_and_b32 s90, s90, 1
    s_or_b32 s90, s90, s31
    s_lshr_b32 s91, s89, 6
    s_and_b32 s31, s91, 2
    s_lshl_b32 s31, s31, 15
    s_and_b32 s91, s91, 1
    s_or_b32 s91, s91, s31
    s_mov_b32 s96, 0
py_loop:
    s_waitcnt vmcnt(0)
    v_xor_b32 v60, s76, v48
    v_xor_b32 v61, s77, v49
    v_xor_b32 v62, s90, v50
    v_xor_b32 v63, s91, v51
    v_or3_b32 v59, v60, v61, v62
    v_or_b32 v59, v59, v63
    v_xor_b32 v60, s76, v52
    v_xor_b32 v61, s77, v53
    v_xor_b32 v62, s90, v54
    v_xor_b32 v63, s91, v55
    v_or3_b32 v59, v59, v60, v61
    v_or3_b32 v59, v59, v62, v63
    v_and_b32 v59, 0x10001, v59
    v_cmp_ne_u32 vcc, 0, v59
    s_cbranch_vccz py_done
    buffer_load_dwordx4 v[48:51], v6, s[80:83], s78 offen offset:0 sc1 nt
    buffer_load_dwordx4 v[52:55], v6, s[80:83], s78 offen offset:1024 sc1 nt
    s_add_u32 s96, s96, 1
    s_cmp_lt_u32 s96, 200000
    s_cbranch_scc1 py_loop
py_done:
    v_and_b32 v48, 0xfffefffe, v48
    v_and_b32 v49, 0xfffefffe, v49
    v_and_b32 v50, 0xfffefffe, v50
    v_and_b32 v51, 0xfffefffe, v51
    v_and_b32 v52, 0xfffefffe, v52
    v_and_b32 v53, 0xfffefffe, v53
    v_and_b32 v54, 0xfffefffe, v54
    v_and_b32 v55, 0xfffefffe, v55
    v_lshlrev_b32 v60, 16, v48
    v_and_b32 v61, 0xffff0000, v48
    v_mul_f32 v96, v32, v60
    v_mul_f32 v97, v32, v61
    v_lshlrev_b32 v60, 16, v49
    v_and_b32 v61, 0xffff0000, v49
    v_mul_f32 v98, v32, v60
    v_mul_f32 v99, v32, v61
    v_lshlrev_b32 v60, 16, v50
    v_and_b32 v61, 0xffff0000, v50
    v_mul_f32 v100, v32, v60
    v_mul_f32 v101, v32, v61
    v_lshlrev_b32 v60, 16, v51
    v_and_b32 v61, 0xffff0000, v51
    v_mul_f32 v102, v32, v60
    v_mul_f32 v103, v32, v61
    v_lshlrev_b32 v60, 16, v52
    v_and_b32 v61, 0xffff0000, v52
    v_fmac_f32 v96, v36, v60
    v_fmac_f32 v97, v36, v61
    v_lshlrev_b32 v60, 16, v53
    v_and_b32 v61, 0xffff0000, v53
    v_fmac_f32 v98, v36, v60
    v_fmac_f32 v99, v36, v61
    v_lshlrev_b32 v60, 16, v54
    v_and_b32 v61, 0xffff0000, v54
    v_fmac_f32 v100, v36, v60
    v_fmac_f32 v101, v36, v61
    v_lshlrev_b32 v60, 16, v55
    v_and_b32 v61, 0xffff0000, v55
    v_fmac_f32 v102, v36, v60
    v_fmac_f32 v103, v36, v61
    v_add_f32 v96, v96, v96 row_ror:8
    v_add_f32 v97, v97, v97 row_ror:8
    v_add_f32 v98, v98, v98 row_ror:8
    v_add_f32 v99, v99, v99 row_ror:8
    v_add_f32 v100, v100, v100 row_ror:8
    v_add_f32 v101, v101, v101 row_ror:8
    v_add_f32 v102, v102, v102 row_ror:8
    v_add_f32 v103, v103, v103 row_ror:8
    v_mov_b32 v48, v96
    v_mov_b32 v49, v97
    v_mov_b32 v50, v98
    v_mov_b32 v51, v99
    v_permlane16_swap_b32 v96, v48
    v_permlane16_swap_b32 v97, v49
    v_permlane16_swap_b32 v98, v50
    v_permlane16_swap_b32 v99, v51
    v_add_f32 v96, v96, v48
    v_add_f32 v97, v97, v49
    v_add_f32 v98, v98, v50
    v_add_f32 v99, v99, v51
    v_mov_b32 v48, v96
    v_mov_b32 v49, v97
    v_mov_b32 v50, v98
    v_mov_b32 v51, v99
    v_permlane32_swap_b32 v96, v48
    v_permlane32_swap_b32 v97, v49
    v_permlane32_swap_b32 v98, v50
    v_permlane32_swap_b32 v99, v51
    v_add_f32 v96, v96, v48
    v_add_f32 v97, v97, v49
    v_add_f32 v98, v98, v50
    v_add_f32 v99, v99, v51
    v_mov_b32 v52, v100
    v_mov_b32 v53, v101
    v_mov_b32 v54, v102
    v_mov_b32 v55, v103
    v_permlane16_swap_b32 v100, v52
    v_permlane16_swap_b32 v101, v53
    v_permlane16_swap_b32 v102, v54
    v_permlane16_swap_b32 v103, v55
    v_add_f32 v100, v100, v52
    v_add_f32 v101, v101, v53
    v_add_f32 v102, v102, v54
    v_add_f32 v103, v103, v55
    v_mov_b32 v52, v100
    v_mov_b32 v53, v101
    v_mov_b32 v54, v102
    v_mov_b32 v55, v103
    v_permlane32_swap_b32 v100, v52
    v_permlane32_swap_b32 v101, v53
    v_permlane32_swap_b32 v102, v54
    v_permlane32_swap_b32 v103, v55
    v_add_f32 v100, v100, v52
    v_add_f32 v101, v101, v53
    v_add_f32 v102, v102, v54
    v_add_f32 v103, v103, v55
    v_cvt_pk_bf16_f32 v104, v96, v97
    v_cvt_pk_bf16_f32 v105, v98, v99
    v_cvt_pk_bf16_f32 v106, v100, v101
    v_cvt_pk_bf16_f32 v107, v102, v103
    v_cmp_gt_u32 vcc, 8, v1
    s_and_saveexec_b64 s[100:101], vcc
    ds_write_b128 v13, v[104:107] offset:13056
    s_mov_b64 exec, s[100:101]
    v_and_b32 v13, 7, v2
    v_mul_u32_u24 v15, 144, v13
    v_lshl_add_u32 v15, v3, 4, v15
    s_waitcnt lgkmcnt(0)
    s_barrier
    ds_read_b128 v[32:35], v15 offset:13056
    ds_read_b128 v[36:39], v15 offset:13120
    v_lshrrev_b32 v10, 2, v2
    v_mul_u32_u24 v14, 1152, v3
    v_lshl_add_u32 v14, v10, 7, v14
    v_lshl_add_u32 v14, v9, 3, v14
    s_and_b32 s92, s84, 3
    v_xor_b32 v10, s92, v10
    v_lshl_add_u32 v10, v10, 5, v14
    v_add_u32 v10, 29696, v10
    ds_read_b64_tr_b16 v[136:137], v10 offset:16384
    ds_read_b64_tr_b16 v[138:139], v10 offset:16896
    ds_read_b64_tr_b16 v[140:141], v10 offset:20992
    ds_read_b64_tr_b16 v[142:143], v10 offset:21504
    ds_read_b64_tr_b16 v[144:145], v10 offset:25600
    ds_read_b64_tr_b16 v[146:147], v10 offset:26112
    ds_read_b64_tr_b16 v[148:149], v10 offset:30208
    ds_read_b64_tr_b16 v[150:151], v10 offset:30720
    v_lshrrev_b32 v11, 1, v2
    v_lshlrev_b32 v11, 9, v11
    v_lshl_add_u32 v11, v3, 4, v11
    s_lshl_b32 s92, s95, 11
    s_lshl_b32 s93, s84, 6
    s_add_u32 s92, s92, s93
    s_add_u32 s92, s92, 1048576
    v_mov_b32 v102, s89
    v_mov_b32 v103, s89
    v_and_b32 v13, 9, v2
    v_cmp_eq_u32 vcc, 0, v13
    s_waitcnt lgkmcnt(8)
    v_mfma_f32_16x16x32_bf16 v[96:99], v[128:131], v[32:35], 0
    v_mfma_f32_16x16x32_bf16 v[96:99], v[132:135], v[36:39], v[96:99]
    s_lshl_b32 s31, s87, 14
    s_lshl_b32 s93, s84, 11
    s_add_u32 s31, s31, s93
    s_add_u32 s31, s31, 1048576
    s_add_u32 s30, s92, 8388608
    s_nop 2
    s_mul_i32 s93, s84, 1088
    v_add_u32 v13, s93, v12
    v_add_f32 v96, v96, v96 quad_perm:[1,0,3,2] row_mask:0xf bank_mask:0xf
    v_add_f32 v97, v97, v97 quad_perm:[1,0,3,2] row_mask:0xf bank_mask:0xf
    v_add_f32 v98, v98, v98 quad_perm:[1,0,3,2] row_mask:0xf bank_mask:0xf
    v_add_f32 v99, v99, v99 quad_perm:[1,0,3,2] row_mask:0xf bank_mask:0xf
    v_cvt_pk_bf16_f32 v100, v96, v97
    v_cvt_pk_bf16_f32 v101, v98, v99
    s_and_saveexec_b64 s[100:101], vcc
    buffer_store_dwordx4 v[100:103], v11, s[80:83], s92 offen
    s_mov_b64 exec, -1
    buffer_load_dwordx4 v[32:35], v6, s[80:83], s31 offen offset:0 sc1
    buffer_load_dwordx4 v[36:39], v6, s[80:83], s31 offen offset:1024 sc1
    s_mov_b64 exec, vcc
    buffer_store_dwordx4 v[100:103], v11, s[80:83], s30 offen sc1
    s_mov_b64 exec, s[100:101]
    s_waitcnt vmcnt(1)
    v_cmp_ne_u32 vcc, s89, v34
    v_cmp_ne_u32 s[100:101], s89, v35
    s_or_b64 vcc, vcc, s[100:101]
    v_cmp_ne_u32 s[100:101], s89, v38
    s_or_b64 vcc, vcc, s[100:101]
    v_cmp_ne_u32 s[100:101], s89, v39
    s_or_b64 vcc, vcc, s[100:101]
    s_cbranch_vccz pc_done
    s_mov_b32 s96, 0
pc_loop:
    s_and_b32 s30, s96, 7
    s_cmp_eq_u32 s30, 7
    s_cselect_b32 s30, 8388608, 0
    s_add_u32 s30, s30, s31
    buffer_load_dwordx4 v[32:35], v6, s[80:83], s30 offen offset:0 sc1
    buffer_load_dwordx4 v[36:39], v6, s[80:83], s30 offen offset:1024 sc1
    s_waitcnt vmcnt(0)
    v_cmp_ne_u32 vcc, s89, v34
    v_cmp_ne_u32 s[100:101], s89, v35
    s_or_b64 vcc, vcc, s[100:101]
    v_cmp_ne_u32 s[100:101], s89, v38
    s_or_b64 vcc, vcc, s[100:101]
    v_cmp_ne_u32 s[100:101], s89, v39
    s_or_b64 vcc, vcc, s[100:101]
    s_cbranch_vccz pc_done
    s_add_u32 s96, s96, 1
    s_sleep 1
    s_cmp_lt_u32 s96, 200000
    s_cbranch_scc1 pc_loop
pc_done:
    ds_write_b64 v13, v[32:33] offset:15104
    ds_write_b64 v13, v[36:37] offset:15648
    s_waitcnt lgkmcnt(0)
    s_barrier
    s_cmp_ge_u32 s84, 4
    s_cbranch_scc1 L_afterE
    ds_read_b128 v[32:35], v5 offset:15104
    ds_read_b128 v[36:39], v5 offset:15168
    ds_read_b128 v[40:43], v5 offset:15232
    ds_read_b128 v[44:47], v5 offset:15296
    ds_read_b128 v[48:51], v5 offset:19456
    ds_read_b128 v[52:55], v5 offset:19520
    ds_read_b128 v[56:59], v5 offset:19584
    ds_read_b128 v[60:63], v5 offset:19648
    v_lshlrev_b32 v11, 13, v2
    v_lshl_add_u32 v11, v3, 4, v11
    s_lshl_b32 s92, s88, 15
    s_lshl_b32 s93, s87, 8
    s_add_u32 s92, s92, s93
    s_lshl_b32 s93, s84, 6
    s_add_u32 s92, s92, s93
    s_add_u32 s92, s92, 1572864
    v_mov_b32 v102, s89
    v_mov_b32 v103, s89
    v_cmp_gt_u32 vcc, 4, v2
    s_waitcnt lgkmcnt(7)
    v_mfma_f32_16x16x32_bf16 v[96:99], v[136:139], v[32:35], 0
    s_waitcnt lgkmcnt(6)
    v_mfma_f32_16x16x32_bf16 v[96:99], v[140:143], v[36:39], v[96:99]
    s_waitcnt lgkmcnt(5)
    v_mfma_f32_16x16x32_bf16 v[96:99], v[144:147], v[40:43], v[96:99]
    s_waitcnt lgkmcnt(4)
    v_mfma_f32_16x16x32_bf16 v[96:99], v[148:151], v[44:47], v[96:99]
    s_waitcnt lgkmcnt(3)
    v_mfma_f32_16x16x32_bf16 v[96:99], v[136:139], v[48:51], v[96:99]
    s_waitcnt lgkmcnt(2)
    v_mfma_f32_16x16x32_bf16 v[96:99], v[140:143], v[52:55], v[96:99]
    s_waitcnt lgkmcnt(1)
    v_mfma_f32_16x16x32_bf16 v[96:99], v[144:147], v[56:59], v[96:99]
    s_waitcnt lgkmcnt(0)
    v_mfma_f32_16x16x32_bf16 v[96:99], v[148:151], v[60:63], v[96:99]
    s_nop 7
    v_add_f32 v96, v96, v96 row_ror:8
    v_add_f32 v97, v97, v97 row_ror:8
    v_add_f32 v98, v98, v98 row_ror:8
    v_add_f32 v99, v99, v99 row_ror:8
    s_nop 0
    v_add_f32 v96, v96, v96 row_ror:4
    v_add_f32 v97, v97, v97 row_ror:4
    v_add_f32 v98, v98, v98 row_ror:4
    v_add_f32 v99, v99, v99 row_ror:4
    s_nop 0
    v_cvt_pk_bf16_f32 v100, v96, v97
    v_cvt_pk_bf16_f32 v101, v98, v99
    s_and_saveexec_b64 s[100:101], vcc
    buffer_store_dwordx4 v[100:103], v11, s[80:83], s92 offen sc1
    s_mov_b64 exec, s[100:101]
L_afterE:
    s_cmp_lt_u32 s86, 28
    s_cbranch_scc1 L_FIN
    s_sub_u32 s94, s86, 28
    s_lshl_b32 s92, s85, 2
    s_add_u32 s92, s92, s94
    s_cmp_lt_u32 s84, 4
    s_cbranch_scc1 L_fin0
    s_mul_i32 s31, s92, 28672
    s_sub_u32 s93, s84, 4
    s_mul_i32 s94, s93, 7168
    s_add_u32 s31, s31, s94
    s_add_u32 s31, s31, 2097152
    s_add_u32 s94, s31, 4096
    s_mov_b32 s96, 0
pf_loop:
    buffer_load_dwordx4 v[32:35], v6, s[80:83], s31 offen offset:0 sc1
    buffer_load_dwordx4 v[36:39], v6, s[80:83], s31 offen offset:1024 sc1
    buffer_load_dwordx4 v[40:43], v6, s[80:83], s31 offen offset:2048 sc1
    buffer_load_dwordx4 v[44:47], v6, s[80:83], s31 offen offset:3072 sc1
    buffer_load_dwordx4 v[48:51], v6, s[80:83], s94 offen offset:0 sc1
    buffer_load_dwordx4 v[52:55], v6, s[80:83], s94 offen offset:1024 sc1
    buffer_load_dwordx4 v[56:59], v6, s[80:83], s94 offen offset:2048 sc1
    s_waitcnt vmcnt(0)
    v_cmp_ne_u32 vcc, s89, v34
    v_cmp_ne_u32 s[100:101], s89, v38
    s_or_b64 vcc, vcc, s[100:101]
    v_cmp_ne_u32 s[100:101], s89, v42
    s_or_b64 vcc, vcc, s[100:101]
    v_cmp_ne_u32 s[100:101], s89, v46
    s_or_b64 vcc, vcc, s[100:101]
    v_cmp_ne_u32 s[100:101], s89, v50
    s_or_b64 vcc, vcc, s[100:101]
    v_cmp_ne_u32 s[100:101], s89, v54
    s_or_b64 vcc, vcc, s[100:101]
    v_cmp_ne_u32 s[100:101], s89, v58
    s_or_b64 vcc, vcc, s[100:101]
    v_cmp_ne_u32 s[100:101], s89, v35
    s_or_b64 vcc, vcc, s[100:101]
    v_cmp_ne_u32 s[100:101], s89, v39
    s_or_b64 vcc, vcc, s[100:101]
    v_cmp_ne_u32 s[100:101], s89, v43
    s_or_b64 vcc, vcc, s[100:101]
    v_cmp_ne_u32 s[100:101], s89, v47
    s_or_b64 vcc, vcc, s[100:101]
    v_cmp_ne_u32 s[100:101], s89, v51
    s_or_b64 vcc, vcc, s[100:101]
    v_cmp_ne_u32 s[100:101], s89, v55
    s_or_b64 vcc, vcc, s[100:101]
    v_cmp_ne_u32 s[100:101], s89, v59
    s_or_b64 vcc, vcc, s[100:101]
    s_cbranch_vccz pf_done
    s_add_u32 s96, s96, 1
    s_sleep 4
    s_cmp_lt_u32 s96, 200000
    s_cbranch_scc1 pf_loop
pf_done:
    v_lshlrev_b32 v96, 16, v32
    v_and_b32 v97, 0xffff0000, v32
    v_lshlrev_b32 v98, 16, v33
    v_and_b32 v99, 0xffff0000, v33
    v_lshlrev_b32 v104, 16, v36
    v_and_b32 v105, 0xffff0000, v36
    v_pk_add_f32 v[96:97], v[96:97], v[104:105]
    v_lshlrev_b32 v104, 16, v37
    v_and_b32 v105, 0xffff0000, v37
    v_pk_add_f32 v[98:99], v[98:99], v[104:105]
    v_lshlrev_b32 v104, 16, v40
    v_and_b32 v105, 0xffff0000, v40
    v_pk_add_f32 v[96:97], v[96:97], v[104:105]
    v_lshlrev_b32 v104, 16, v41
    v_and_b32 v105, 0xffff0000, v41
    v_pk_add_f32 v[98:99], v[98:99], v[104:105]
    v_lshlrev_b32 v104, 16, v44
    v_and_b32 v105, 0xffff0000, v44
    v_pk_add_f32 v[96:97], v[96:97], v[104:105]
    v_lshlrev_b32 v104, 16, v45
    v_and_b32 v105, 0xffff0000, v45
    v_pk_add_f32 v[98:99], v[98:99], v[104:105]
    v_lshlrev_b32 v104, 16, v48
    v_and_b32 v105, 0xffff0000, v48
    v_pk_add_f32 v[96:97], v[96:97], v[104:105]
    v_lshlrev_b32 v104, 16, v49
    v_and_b32 v105, 0xffff0000, v49
    v_pk_add_f32 v[98:99], v[98:99], v[104:105]
    v_lshlrev_b32 v104, 16, v52
    v_and_b32 v105, 0xffff0000, v52
    v_pk_add_f32 v[96:97], v[96:97], v[104:105]
    v_lshlrev_b32 v104, 16, v53
    v_and_b32 v105, 0xffff0000, v53
    v_pk_add_f32 v[98:99], v[98:99], v[104:105]
    v_lshlrev_b32 v104, 16, v56
    v_and_b32 v105, 0xffff0000, v56
    v_pk_add_f32 v[96:97], v[96:97], v[104:105]
    v_lshlrev_b32 v104, 16, v57
    v_and_b32 v105, 0xffff0000, v57
    v_pk_add_f32 v[98:99], v[98:99], v[104:105]
    v_mov_b32 v104, v96
    v_mov_b32 v105, v97
    v_mov_b32 v106, v98
    v_mov_b32 v107, v99
    v_permlane16_swap_b32 v96, v104
    v_permlane16_swap_b32 v97, v105
    v_permlane16_swap_b32 v98, v106
    v_permlane16_swap_b32 v99, v107
    v_add_f32 v96, v96, v104
    v_add_f32 v97, v97, v105
    v_add_f32 v98, v98, v106
    v_add_f32 v99, v99, v107
    v_mov_b32 v104, v96
    v_mov_b32 v105, v97
    v_mov_b32 v106, v98
    v_mov_b32 v107, v99
    v_permlane32_swap_b32 v96, v104
    v_permlane32_swap_b32 v97, v105
    v_permlane32_swap_b32 v98, v106
    v_permlane32_swap_b32 v99, v107
    v_add_f32 v96, v96, v104
    v_add_f32 v97, v97, v105
    v_add_f32 v98, v98, v106
    v_add_f32 v99, v99, v107
    s_lshl_b32 s93, s93, 8
    v_lshlrev_b32 v13, 4, v2
    v_add_u32 v13, s93, v13
    ds_write_b128 v13, v[96:99] offset:9728
    s_waitcnt lgkmcnt(0)
    s_barrier
    s_branch L_FIN
L_fin0:
    s_lshl_b32 s31, s92, 13
    s_lshl_b32 s93, s84, 11
    s_add_u32 s31, s31, s93
    s_add_u32 s31, s31, 1572864
    v_lshlrev_b32 v13, 3, v2
    s_lshl_b32 s93, s85, 7
    s_lshl_b32 s94, s94, 10
    s_add_u32 s94, s94, s93
    s_mov_b32 s96, 0
pp_loop:
    buffer_load_dwordx4 v[32:35], v6, s[80:83], s31 offen offset:0 sc1
    buffer_load_dwordx4 v[36:39], v6, s[80:83], s31 offen offset:1024 sc1
    s_waitcnt vmcnt(0)
    v_cmp_ne_u32 vcc, s89, v34
    v_cmp_ne_u32 s[100:101], s89, v35
    s_or_b64 vcc, vcc, s[100:101]
    v_cmp_ne_u32 s[100:101], s89, v38
    s_or_b64 vcc, vcc, s[100:101]
    v_cmp_ne_u32 s[100:101], s89, v39
    s_or_b64 vcc, vcc, s[100:101]
    s_cbranch_vccz pp_done
    s_add_u32 s96, s96, 1
    s_sleep 1
    s_cmp_lt_u32 s96, 200000
    s_cbranch_scc1 pp_loop
pp_done:
    v_lshlrev_b32 v96, 16, v32
    v_and_b32 v97, 0xffff0000, v32
    v_lshlrev_b32 v98, 16, v33
    v_and_b32 v99, 0xffff0000, v33
    v_lshlrev_b32 v104, 16, v36
    v_and_b32 v105, 0xffff0000, v36
    v_pk_add_f32 v[96:97], v[96:97], v[104:105]
    v_lshlrev_b32 v104, 16, v37
    v_and_b32 v105, 0xffff0000, v37
    v_pk_add_f32 v[98:99], v[98:99], v[104:105]
    v_mov_b32 v104, v96
    v_mov_b32 v105, v97
    v_mov_b32 v106, v98
    v_mov_b32 v107, v99
    v_permlane16_swap_b32 v96, v104
    v_permlane16_swap_b32 v97, v105
    v_permlane16_swap_b32 v98, v106
    v_permlane16_swap_b32 v99, v107
    v_add_f32 v96, v96, v104
    v_add_f32 v97, v97, v105
    v_add_f32 v98, v98, v106
    v_add_f32 v99, v99, v107
    v_mov_b32 v104, v96
    v_mov_b32 v105, v97
    v_mov_b32 v106, v98
    v_mov_b32 v107, v99
    v_permlane32_swap_b32 v96, v104
    v_permlane32_swap_b32 v97, v105
    v_permlane32_swap_b32 v98, v106
    v_permlane32_swap_b32 v99, v107
    v_add_f32 v96, v96, v104
    v_add_f32 v97, v97, v105
    v_add_f32 v98, v98, v106
    v_add_f32 v99, v99, v107
    s_lshl_b32 s93, s84, 8
    v_lshlrev_b32 v15, 4, v2
    v_add_u32 v14, s93, v15
    ds_write_b128 v14, v[96:99] offset:4352
    s_waitcnt lgkmcnt(0)
    s_barrier
    s_cmp_lg_u32 s84, 0
    s_cbranch_scc1 L_FIN
    ds_read_b128 v[32:35], v15 offset:9728
    ds_read_b128 v[36:39], v15 offset:9984
    ds_read_b128 v[40:43], v15 offset:10240
    ds_read_b128 v[44:47], v15 offset:10496
    ds_read_b128 v[48:51], v15 offset:4608
    ds_read_b128 v[52:55], v15 offset:4864
    ds_read_b128 v[56:59], v15 offset:5120
    v_lshlrev_b32 v104, 16, v64
    v_and_b32 v105, 0xffff0000, v64
    v_pk_add_f32 v[96:97], v[96:97], v[104:105]
    v_lshlrev_b32 v104, 16, v66
    v_and_b32 v105, 0xffff0000, v66
    v_pk_add_f32 v[96:97], v[96:97], v[104:105]
    v_lshlrev_b32 v104, 16, v65
    v_and_b32 v105, 0xffff0000, v65
    v_pk_add_f32 v[98:99], v[98:99], v[104:105]
    v_lshlrev_b32 v104, 16, v67
    v_and_b32 v105, 0xffff0000, v67
    v_pk_add_f32 v[98:99], v[98:99], v[104:105]
    s_waitcnt lgkmcnt(0)
    v_pk_add_f32 v[96:97], v[96:97], v[32:33]
    v_pk_add_f32 v[98:99], v[98:99], v[34:35]
    v_pk_add_f32 v[96:97], v[96:97], v[36:37]
    v_pk_add_f32 v[98:99], v[98:99], v[38:39]
    v_pk_add_f32 v[96:97], v[96:97], v[40:41]
    v_pk_add_f32 v[98:99], v[98:99], v[42:43]
    v_pk_add_f32 v[96:97], v[96:97], v[44:45]
    v_pk_add_f32 v[98:99], v[98:99], v[46:47]
    v_pk_add_f32 v[96:97], v[96:97], v[48:49]
    v_pk_add_f32 v[98:99], v[98:99], v[50:51]
    v_pk_add_f32 v[96:97], v[96:97], v[52:53]
    v_pk_add_f32 v[98:99], v[98:99], v[54:55]
    v_pk_add_f32 v[96:97], v[96:97], v[56:57]
    v_pk_add_f32 v[98:99], v[98:99], v[58:59]
    v_cvt_pk_bf16_f32 v100, v96, v97
    v_cvt_pk_bf16_f32 v101, v98, v99
    v_cmp_gt_u32 vcc, 16, v1
    s_and_saveexec_b64 s[100:101], vcc
    buffer_store_dwordx2 v[100:101], v13, s[72:75], s94 offen
    s_mov_b64 exec, s[100:101]
    s_cmp_lg_u32 s2, 248
    s_cbranch_scc1 L_FIN
    v_mov_b32 v100, s89
    v_cmp_eq_u32 vcc, 0, v1
    s_and_saveexec_b64 s[100:101], vcc
    buffer_store_dword v100, v7, s[80:83], 0 offen sc1
    s_mov_b64 exec, s[100:101]
L_FIN:
L_END:
    s_endpgm
.section .rodata,"a"
.p2align 6
.amdhsa_kernel parallel_sum__compressed_kv_cla__dense_activation_squared_relu__decode_kernel
  .amdhsa_next_free_vgpr 256
  .amdhsa_next_free_sgpr 102
  .amdhsa_accum_offset 256
  .amdhsa_group_segment_fixed_size 0
  .amdhsa_kernarg_size 112
  .amdhsa_user_sgpr_count 2
  .amdhsa_user_sgpr_kernarg_segment_ptr 1
  .amdhsa_system_sgpr_workgroup_id_x 1
.end_amdhsa_kernel
```
